```python
import torch

def _softmax(x, axis=-1):
    return torch.softmax(x, dim=axis)

def _gelu(x):
    return torch.nn.functional.gelu(x, approximate='tanh')

def _silu(x):
    return torch.nn.functional.silu(x)

def _sigmoid(x):
    return torch.sigmoid(x)

def _layernorm(x, axis=-1, eps=1e-05):
    m = x.mean(dim=axis, keepdim=True)
    v = x.var(dim=axis, keepdim=True, unbiased=False)
    return (x - m) / torch.sqrt(v + eps)

def _scatter_add(tgt, idx, src, axis=0):
    return tgt.clone().index_add_(axis, idx, src)

def _segment_sum(src, seg, n):
    out = torch.zeros((n,) + src.shape[1:], dtype=src.dtype)
    return out.index_add_(0, seg, src)

def _pad(x, pw):
    flat = tuple((v for pair in reversed(pw) for v in pair))
    return torch.nn.functional.pad(x, flat)
kernel_name = 'adaLN_cond__spectral_fnet__glu_gated_glu__prompt'

def setup_inputs():

    _w = lambda a: (lambda t: t.to(torch.bfloat16) if t.is_floating_point() else t)(torch.as_tensor(a))

    def _A_setup():
        B, S, D = (1, 2048, 448)
        ns = torch.arange(S)[:, None] * torch.arange(S)[None, :]
        nd = torch.arange(D)[:, None] * torch.arange(D)[None, :]
        Ws_re = torch.cos(-2.0 * torch.pi * ns / S).to(float)
        Ws_im = torch.sin(-2.0 * torch.pi * ns / S).to(float)
        Wd_re = torch.cos(-2.0 * torch.pi * nd / D).to(float)
        Wd_im = torch.sin(-2.0 * torch.pi * nd / D).to(float)
        return {'x': _w((lambda *s: torch.randn(*s, dtype=torch.bfloat16) * 0.05)(B, S, D)), 'dft_seq_re': _w(Ws_re), 'dft_seq_im': _w(Ws_im), 'dft_hid_re': _w(Wd_re), 'dft_hid_im': _w(Wd_im)}
    _A_in = _A_setup()

    def _B_setup():
        B, S, D, F = (1, 2048, 448, 1792)
        return {'x': _w((lambda *s: torch.randn(*s, dtype=torch.bfloat16) * 0.05)(B, S, D)), 'w_gate': _w((lambda *s: torch.randn(*s, dtype=torch.bfloat16) * 3.2)(D, F)), 'w_up': _w((lambda *s: torch.randn(*s, dtype=torch.bfloat16) * 1.6)(D, F)), 'w_down': _w((lambda *s: torch.randn(*s, dtype=torch.bfloat16) * 1.6)(F, D))}
    _B_in = _B_setup()
    return {'A_x': _A_in['x'], 'A_dft_seq_re': _A_in['dft_seq_re'], 'A_dft_seq_im': _A_in['dft_seq_im'], 'A_dft_hid_re': _A_in['dft_hid_re'], 'A_dft_hid_im': _A_in['dft_hid_im'], 'B_x': _B_in['x'], 'B_w_gate': _B_in['w_gate'], 'B_w_up': _B_in['w_up'], 'B_w_down': _B_in['w_down'], 'c': _w((lambda *s: torch.randn(*s, dtype=torch.bfloat16) * 0.1)(1, 448) * 8.0), 'w_mod': _w((lambda *s: torch.randn(*s, dtype=torch.bfloat16) * 0.1)(448, 6 * 448) * 448 ** (-0.5) * 8.0)}

def reference(A_x, A_dft_seq_re, A_dft_seq_im, A_dft_hid_re, A_dft_hid_im, B_x, B_w_gate, B_w_up, B_w_down, c, w_mod):

    def _A_ref(x, dft_seq_re, dft_seq_im, dft_hid_re, dft_hid_im):
        a = torch.einsum('bsd,ed->bse', x, dft_hid_re)
        b = torch.einsum('bsd,ed->bse', x, dft_hid_im)
        y = torch.einsum('ts,bse->bte', dft_seq_re, a) - torch.einsum('ts,bse->bte', dft_seq_im, b)
        return y

    def _B_ref(x, w_gate, w_up, w_down):
        g = torch.einsum('bsd,df->bsf', x, w_gate)
        u = torch.einsum('bsd,df->bsf', x, w_up)
        h = _sigmoid(g) * u
        return torch.einsum('bsf,fd->bsd', h, w_down)
    x = A_x
    mod = (_silu(c) @ w_mod).reshape(c.shape[0], 6, 1, -1)
    sa, ca, ga, sb, cb, gb = (mod[:, 0].clone(), mod[:, 1].clone(), mod[:, 2].clone(), mod[:, 3].clone(), mod[:, 4].clone(), mod[:, 5].clone())
    h = _layernorm(x, axis=-1) * (1 + ca) + sa
    x = x + ga * _A_ref(h, A_dft_seq_re, A_dft_seq_im, A_dft_hid_re, A_dft_hid_im)
    h = _layernorm(x, axis=-1) * (1 + cb) + sb
    x = x + gb * _B_ref(h, B_w_gate, B_w_up, B_w_down)
    return x
```

```asm
; @launch grid=(256,1,1) block=(256,1,1) lds=163840
.amdgcn_target "amdgcn-amd-amdhsa--gfx950"
.text
.globl adaLN_cond__spectral_fnet__glu_gated_glu__prompt_kernel
.p2align 8
.type adaLN_cond__spectral_fnet__glu_gated_glu__prompt_kernel,@function
adaLN_cond__spectral_fnet__glu_gated_glu__prompt_kernel:
    s_cmp_ge_u32 s2, 256
    s_cbranch_scc1 K_END
    s_load_dwordx2 s[4:5], s[0:1], 0
    s_load_dwordx2 s[8:9], s[0:1], 104
    s_load_dwordx2 s[24:25], s[0:1], 96
    s_load_dwordx2 s[12:13], s[0:1], 48
    s_load_dwordx2 s[16:17], s[0:1], 56
    s_load_dwordx2 s[20:21], s[0:1], 88
    s_load_dwordx2 s[56:57], s[0:1], 80
    s_getpc_b64 s[52:53]
M_PC:
    s_bfe_u32 s3, s2, 0x20003
    s_lshl_b32 s3, s3, 13
    v_lshl_add_u32 v2, v0, 5, s3
    v_min_u32 v2, K_LAST-M_PC, v2
    v_mov_b32 v3, s53
    v_add_co_u32 v2, vcc, s52, v2
    s_nop 1
    v_addc_co_u32 v3, vcc, 0, v3, vcc
    global_load_dword a254, v[2:3], off
    s_cmp_lt_u32 s2, 4
    s_cbranch_scc1 K_ZERO
    s_cmp_lt_u32 s2, 32
    s_cbranch_scc1 K_HELP
    s_mov_b32 s6, 1835008
    s_mov_b32 s7, 0x00020000
    v_lshrrev_b32 v5, 6, v0
    v_and_b32 v1, 63, v0
    v_readfirstlane_b32 s30, v5
    s_lshr_b32 s29, s2, 3
    s_sub_u32 s29, s29, 4
    s_mul_i32 s28, s29, 37
    s_lshr_b32 s28, s28, 8
    s_mul_i32 s3, s28, 7
    s_sub_u32 s29, s29, s3
    s_and_b32 s3, s2, 7
    s_lshl_b32 s3, s3, 2
    s_add_u32 s28, s28, s3
    v_lshrrev_b32 v6, 3, v1
    v_lshl_add_u32 v6, v5, 4, v6
    v_mul_u32_u24 v7, 28672, v6
    v_and_b32 v8, 7, v1
    v_lshl_add_u32 v7, v8, 4, v7
    v_add_u32 v9, 229376, v7
    s_mul_i32 s36, s28, 896
    s_lshl_b32 s35, s29, 7
    s_add_u32 s35, s35, s36
    s_add_u32 s37, s36, 896
    s_mov_b32 s58, 2408448
    s_mov_b32 s59, 0x00020000
    s_sub_u32 s3, s2, 32
    s_min_u32 s3, s3, 191
    s_mul_i32 s40, s3, 1366
    s_lshr_b32 s40, s40, 16
    s_add_u32 s40, s40, 1
    s_lshl_b32 s40, s40, 6
    s_add_u32 s3, s3, s40
    s_mul_i32 s3, s3, 5376
    s_mul_i32 s40, s30, 896
    s_cmp_eq_u32 s30, 3
    s_cselect_b32 s40, 3584, s40
    s_add_u32 s3, s3, s40
    v_add_u32 v11, 57, v1
    v_mul_u32_u24 v10, 128, v1
    v_lshrrev_b32 v11, 6, v11
    v_lshl_add_u32 v10, v11, 30, v10
    s_waitcnt lgkmcnt(0)
    buffer_load_dwordx4 v[16:19], v7, s[4:7], s35 offen
    buffer_load_dwordx4 v[44:47], v9, s[4:7], s35 offen
    s_add_u32 s35, s35, 128
    s_cmp_eq_u32 s35, s37
    s_cselect_b32 s35, s36, s35
    buffer_load_dword a253, v10, s[56:59], s3 offen
    buffer_load_dwordx4 v[20:23], v7, s[4:7], s35 offen
    buffer_load_dwordx4 v[48:51], v9, s[4:7], s35 offen
    s_add_u32 s35, s35, 128
    s_cmp_eq_u32 s35, s37
    s_cselect_b32 s35, s36, s35
    buffer_load_dwordx4 v[24:27], v7, s[4:7], s35 offen
    buffer_load_dwordx4 v[52:55], v9, s[4:7], s35 offen
    s_add_u32 s35, s35, 128
    s_cmp_eq_u32 s35, s37
    s_cselect_b32 s35, s36, s35
    buffer_load_dwordx4 v[28:31], v7, s[4:7], s35 offen
    buffer_load_dwordx4 v[56:59], v9, s[4:7], s35 offen
    s_add_u32 s35, s35, 128
    s_cmp_eq_u32 s35, s37
    s_cselect_b32 s35, s36, s35
    s_branch K_MAIN
K_ZERO:
    s_mov_b32 s10, 268435456
    s_mov_b32 s11, 0x00020000
    s_mov_b32 s26, 256
    s_mov_b32 s27, 0x00020000
    v_lshlrev_b32 v2, 4, v0
    v_mov_b32 v4, 0
    v_mov_b32 v5, 0
    v_mov_b32 v6, 0
    v_mov_b32 v7, 0
    s_mul_i32 s3, s2, 12288
    s_add_u32 s3, s3, 2539520
    s_waitcnt lgkmcnt(0)
    buffer_store_dwordx4 v[4:7], v2, s[8:11], s3 offen sc1
    s_add_u32 s3, s3, 4096
    buffer_store_dwordx4 v[4:7], v2, s[8:11], s3 offen sc1
    s_add_u32 s3, s3, 4096
    buffer_store_dwordx4 v[4:7], v2, s[8:11], s3 offen sc1
    s_add_u32 s3, s3, 4096
    v_lshlrev_b32 v8, 10, v0
    v_mov_b32 v9, 1
    s_lshl_b32 s3, s2, 2
    s_waitcnt vmcnt(0)
    s_barrier
    buffer_store_dword v9, v8, s[24:27], s3 offen sc1
    s_branch K_HELP
K_MAIN:
    s_mov_b32 s10, 268435456
    s_mov_b32 s11, 0x00020000
    s_mov_b32 s26, 256
    s_mov_b32 s27, 0x00020000
    s_mov_b32 s14, 1605632
    s_mov_b32 s15, 0x00020000
    s_mov_b32 s18, 1605632
    s_mov_b32 s19, 0x00020000
    s_mov_b32 s22, 1835008
    s_mov_b32 s23, 0x00020000
    v_lshlrev_b32 v2, 4, v1
    v_and_b32 v3, 31, v1
    v_lshrrev_b32 v4, 5, v1
    v_lshlrev_b32 v94, 2, v4
    v_cvt_f32_u32 v94, v94
    v_cmp_eq_u32 vcc, 0, v3
    s_lshr_b32 s3, s30, 1
    s_lshl_b32 s40, s3, 5
    s_lshl_b32 s3, s3, 4
    v_mov_b32 v92, s40
    v_mov_b32 v93, s3
    v_cndmask_b32 v92, v3, v92, vcc
    v_cndmask_b32 v93, v93, 0, vcc
    v_cvt_f32_u32 v92, v92
    v_cvt_f32_u32 v93, v93
    v_mul_f32 v96, 0x3e000000, v92
    v_mul_f32 v92, 0x3c800000, v92
    v_mul_f32 v93, 0x3c800000, v93
    v_cos_f32 v96, v96
    v_fmac_f32 v93, v94, v92
    v_fmamk_f32 v144, v92, 0x00000000, v93
    v_fmamk_f32 v145, v92, 0x3f800000, v93
    v_fmamk_f32 v146, v92, 0x40000000, v93
    v_fmamk_f32 v147, v92, 0x40400000, v93
    v_fmamk_f32 v148, v92, 0x41000000, v93
    v_fmamk_f32 v149, v92, 0x41100000, v93
    v_fmamk_f32 v150, v92, 0x41200000, v93
    v_fmamk_f32 v151, v92, 0x41300000, v93
    v_add_f32 v96, v96, v96
    v_cos_f32 v144, v144
    v_cos_f32 v145, v145
    v_cos_f32 v146, v146
    v_cos_f32 v147, v147
    v_cos_f32 v148, v148
    v_cos_f32 v149, v149
    v_cos_f32 v150, v150
    v_cos_f32 v151, v151
    v_mov_b32 v97, v96
    v_pk_fma_f32 v[152:153], v[148:149], v[96:97], v[144:145] neg_lo:[0,0,1] neg_hi:[0,0,1]
    v_pk_fma_f32 v[154:155], v[150:151], v[96:97], v[146:147] neg_lo:[0,0,1] neg_hi:[0,0,1]
    v_pk_fma_f32 v[156:157], v[152:153], v[96:97], v[148:149] neg_lo:[0,0,1] neg_hi:[0,0,1]
    v_pk_fma_f32 v[158:159], v[154:155], v[96:97], v[150:151] neg_lo:[0,0,1] neg_hi:[0,0,1]
    v_pk_fma_f32 v[160:161], v[156:157], v[96:97], v[152:153] neg_lo:[0,0,1] neg_hi:[0,0,1]
    v_pk_fma_f32 v[162:163], v[158:159], v[96:97], v[154:155] neg_lo:[0,0,1] neg_hi:[0,0,1]
    v_pk_fma_f32 v[164:165], v[160:161], v[96:97], v[156:157] neg_lo:[0,0,1] neg_hi:[0,0,1]
    v_pk_fma_f32 v[166:167], v[162:163], v[96:97], v[158:159] neg_lo:[0,0,1] neg_hi:[0,0,1]
    v_pk_fma_f32 v[168:169], v[164:165], v[96:97], v[160:161] neg_lo:[0,0,1] neg_hi:[0,0,1]
    v_pk_fma_f32 v[170:171], v[166:167], v[96:97], v[162:163] neg_lo:[0,0,1] neg_hi:[0,0,1]
    v_pk_fma_f32 v[172:173], v[168:169], v[96:97], v[164:165] neg_lo:[0,0,1] neg_hi:[0,0,1]
    v_pk_fma_f32 v[174:175], v[170:171], v[96:97], v[166:167] neg_lo:[0,0,1] neg_hi:[0,0,1]
    v_cvt_pk_f16_f32 v72, v144, v145
    v_cvt_pk_f16_f32 v73, v146, v147
    v_cvt_pk_f16_f32 v74, v148, v149
    v_cvt_pk_f16_f32 v75, v150, v151
    v_cvt_pk_f16_f32 v76, v152, v153
    v_cvt_pk_f16_f32 v77, v154, v155
    v_cvt_pk_f16_f32 v78, v156, v157
    v_cvt_pk_f16_f32 v79, v158, v159
    v_cvt_pk_f16_f32 v80, v160, v161
    v_cvt_pk_f16_f32 v81, v162, v163
    v_cvt_pk_f16_f32 v82, v164, v165
    v_cvt_pk_f16_f32 v83, v166, v167
    v_cvt_pk_f16_f32 v84, v168, v169
    v_cvt_pk_f16_f32 v85, v170, v171
    v_cvt_pk_f16_f32 v86, v172, v173
    v_cvt_pk_f16_f32 v87, v174, v175
    v_mov_b32 v15, 0
    v_and_b32 v95, 3, v1
    v_lshlrev_b32 v100, 4, v95
    v_lshl_add_u32 v100, v6, 6, v100
    v_bfe_u32 v96, v1, 2, 1
    v_lshl_add_u32 v100, v96, 12, v100
    v_lshlrev_b32 v101, 8, v4
    v_bfe_u32 v96, v1, 2, 2
    v_lshl_add_u32 v101, v96, 6, v101
    v_bfe_u32 v96, v1, 4, 1
    v_lshl_add_u32 v101, v96, 5, v101
    v_lshl_add_u32 v101, v95, 3, v101
    s_and_b32 s3, s30, 1
    s_cselect_b32 s44, s16, s12
    s_cselect_b32 s45, s17, s13
    s_mov_b32 s46, 1605632
    s_mov_b32 s47, 0x00020000
    s_lshl_b32 s40, s3, 12
    v_add_u32 v101, s40, v101
    v_add_u32 v107, 36, v1
    v_mul_u32_u24 v106, 1792, v1
    v_lshrrev_b32 v107, 6, v107
    v_lshl_add_u32 v106, v107, 30, v106
    s_sub_u32 s49, s2, 32
    s_lshl_b32 s49, s49, 1
    s_lshr_b32 s40, s30, 1
    s_add_u32 s49, s49, s40
    s_mul_i32 s49, s49, 3584
    s_and_b32 s3, s2, 1
    s_mul_i32 s3, s3, 7
    s_add_u32 s32, s29, s3
    s_and_b32 s3, s28, 3
    s_lshr_b32 s31, s28, 3
    s_lshl_b32 s31, s31, 2
    s_add_u32 s31, s31, s3
    v_lshrrev_b32 v92, 4, v1
    v_lshlrev_b32 v93, 2, v92
    v_and_b32 v11, 15, v1
    v_xor_b32 v11, v11, v93
    v_lshlrev_b32 v11, 4, v11
    v_lshl_add_u32 v92, s30, 2, v92
    v_mul_u32_u24 v92, 3584, v92
    s_lshl_b32 s3, s32, 8
    v_add3_u32 v11, v11, v92, s3
    s_lshl_b32 s42, s30, 10
    s_add_u32 s42, s42, 16384
    v_and_b32 v107, 1, v1
    v_mul_u32_u24 v107, 1664, v107
    v_sub_u32 v106, v106, v107
    s_lshl_b32 s49, s31, 1
    s_add_u32 s49, s49, s40
    s_mul_i32 s49, s49, 50176
    s_add_u32 s49, s49, s3
    buffer_load_dwordx4 v[32:35], v7, s[4:7], s35 offen
    buffer_load_dwordx4 v[60:63], v9, s[4:7], s35 offen
    s_add_u32 s35, s35, 128
    s_cmp_eq_u32 s35, s37
    s_cselect_b32 s35, s36, s35
    buffer_load_dwordx4 v[36:39], v7, s[4:7], s35 offen
    buffer_load_dwordx4 v[64:67], v9, s[4:7], s35 offen
    s_add_u32 s35, s35, 128
    s_cmp_eq_u32 s35, s37
    s_cselect_b32 s35, s36, s35
    buffer_load_dwordx4 v[40:43], v7, s[4:7], s35 offen
    buffer_load_dwordx4 v[68:71], v9, s[4:7], s35 offen
    v_mov_b32 v88, 0
    v_mov_b32 v89, 0
    v_mov_b32 v90, 0
    v_mov_b32 v91, 0
    s_mov_b32 s3, 0x3f803f80
    s_waitcnt vmcnt(14)
    v_dot2c_f32_bf16 v88, s3, v16
    v_dot2c_f32_bf16 v89, v16, v16
    s_waitcnt vmcnt(13)
    v_dot2c_f32_bf16 v90, s3, v44
    v_dot2c_f32_bf16 v91, v44, v44
    v_dot2c_f32_bf16 v88, s3, v17
    v_dot2c_f32_bf16 v89, v17, v17
    v_dot2c_f32_bf16 v90, s3, v45
    v_dot2c_f32_bf16 v91, v45, v45
    v_dot2c_f32_bf16 v88, s3, v18
    v_dot2c_f32_bf16 v89, v18, v18
    v_dot2c_f32_bf16 v90, s3, v46
    v_dot2c_f32_bf16 v91, v46, v46
    v_dot2c_f32_bf16 v88, s3, v19
    v_dot2c_f32_bf16 v89, v19, v19
    v_dot2c_f32_bf16 v90, s3, v47
    v_dot2c_f32_bf16 v91, v47, v47
    s_waitcnt vmcnt(11)
    v_dot2c_f32_bf16 v88, s3, v20
    v_dot2c_f32_bf16 v89, v20, v20
    s_waitcnt vmcnt(10)
    v_dot2c_f32_bf16 v90, s3, v48
    v_dot2c_f32_bf16 v91, v48, v48
    v_dot2c_f32_bf16 v88, s3, v21
    v_dot2c_f32_bf16 v89, v21, v21
    v_dot2c_f32_bf16 v90, s3, v49
    v_dot2c_f32_bf16 v91, v49, v49
    v_dot2c_f32_bf16 v88, s3, v22
    v_dot2c_f32_bf16 v89, v22, v22
    v_dot2c_f32_bf16 v90, s3, v50
    v_dot2c_f32_bf16 v91, v50, v50
    v_dot2c_f32_bf16 v88, s3, v23
    v_dot2c_f32_bf16 v89, v23, v23
    v_dot2c_f32_bf16 v90, s3, v51
    v_dot2c_f32_bf16 v91, v51, v51
    s_waitcnt vmcnt(9)
    v_dot2c_f32_bf16 v88, s3, v24
    v_dot2c_f32_bf16 v89, v24, v24
    s_waitcnt vmcnt(8)
    v_dot2c_f32_bf16 v90, s3, v52
    v_dot2c_f32_bf16 v91, v52, v52
    v_dot2c_f32_bf16 v88, s3, v25
    v_dot2c_f32_bf16 v89, v25, v25
    v_dot2c_f32_bf16 v90, s3, v53
    v_dot2c_f32_bf16 v91, v53, v53
    v_dot2c_f32_bf16 v88, s3, v26
    v_dot2c_f32_bf16 v89, v26, v26
    v_dot2c_f32_bf16 v90, s3, v54
    v_dot2c_f32_bf16 v91, v54, v54
    v_dot2c_f32_bf16 v88, s3, v27
    v_dot2c_f32_bf16 v89, v27, v27
    v_dot2c_f32_bf16 v90, s3, v55
    v_dot2c_f32_bf16 v91, v55, v55
    s_waitcnt vmcnt(7)
    v_dot2c_f32_bf16 v88, s3, v28
    v_dot2c_f32_bf16 v89, v28, v28
    s_waitcnt vmcnt(6)
    v_dot2c_f32_bf16 v90, s3, v56
    v_dot2c_f32_bf16 v91, v56, v56
    v_dot2c_f32_bf16 v88, s3, v29
    v_dot2c_f32_bf16 v89, v29, v29
    v_dot2c_f32_bf16 v90, s3, v57
    v_dot2c_f32_bf16 v91, v57, v57
    v_dot2c_f32_bf16 v88, s3, v30
    v_dot2c_f32_bf16 v89, v30, v30
    v_dot2c_f32_bf16 v90, s3, v58
    v_dot2c_f32_bf16 v91, v58, v58
    v_dot2c_f32_bf16 v88, s3, v31
    v_dot2c_f32_bf16 v89, v31, v31
    v_dot2c_f32_bf16 v90, s3, v59
    v_dot2c_f32_bf16 v91, v59, v59
    s_waitcnt vmcnt(5)
    v_dot2c_f32_bf16 v88, s3, v32
    v_dot2c_f32_bf16 v89, v32, v32
    s_waitcnt vmcnt(4)
    v_dot2c_f32_bf16 v90, s3, v60
    v_dot2c_f32_bf16 v91, v60, v60
    v_dot2c_f32_bf16 v88, s3, v33
    v_dot2c_f32_bf16 v89, v33, v33
    v_dot2c_f32_bf16 v90, s3, v61
    v_dot2c_f32_bf16 v91, v61, v61
    v_dot2c_f32_bf16 v88, s3, v34
    v_dot2c_f32_bf16 v89, v34, v34
    v_dot2c_f32_bf16 v90, s3, v62
    v_dot2c_f32_bf16 v91, v62, v62
    v_dot2c_f32_bf16 v88, s3, v35
    v_dot2c_f32_bf16 v89, v35, v35
    v_dot2c_f32_bf16 v90, s3, v63
    v_dot2c_f32_bf16 v91, v63, v63
    s_waitcnt vmcnt(3)
    v_dot2c_f32_bf16 v88, s3, v36
    v_dot2c_f32_bf16 v89, v36, v36
    s_waitcnt vmcnt(2)
    v_dot2c_f32_bf16 v90, s3, v64
    v_dot2c_f32_bf16 v91, v64, v64
    v_dot2c_f32_bf16 v88, s3, v37
    v_dot2c_f32_bf16 v89, v37, v37
    v_dot2c_f32_bf16 v90, s3, v65
    v_dot2c_f32_bf16 v91, v65, v65
    v_dot2c_f32_bf16 v88, s3, v38
    v_dot2c_f32_bf16 v89, v38, v38
    v_dot2c_f32_bf16 v90, s3, v66
    v_dot2c_f32_bf16 v91, v66, v66
    v_dot2c_f32_bf16 v88, s3, v39
    v_dot2c_f32_bf16 v89, v39, v39
    v_dot2c_f32_bf16 v90, s3, v67
    v_dot2c_f32_bf16 v91, v67, v67
    buffer_load_dword a252, v106, s[44:47], s49 offen
    s_add_u32 m0, s42, 57344
    s_mov_b32 s41, 0
    buffer_load_dwordx4 v11, s[12:15], s41 offen lds
    s_add_u32 m0, s42, 61440
    s_mov_b32 s41, 57344
    buffer_load_dwordx4 v11, s[12:15], s41 offen lds
    s_add_u32 m0, s42, 65536
    s_mov_b32 s41, 114688
    buffer_load_dwordx4 v11, s[12:15], s41 offen lds
    s_add_u32 m0, s42, 69632
    s_mov_b32 s41, 172032
    buffer_load_dwordx4 v11, s[12:15], s41 offen lds
    s_waitcnt vmcnt(6)
    v_dot2c_f32_bf16 v88, s3, v40
    v_dot2c_f32_bf16 v89, v40, v40
    s_waitcnt vmcnt(5)
    v_dot2c_f32_bf16 v90, s3, v68
    v_dot2c_f32_bf16 v91, v68, v68
    v_dot2c_f32_bf16 v88, s3, v41
    v_dot2c_f32_bf16 v89, v41, v41
    v_dot2c_f32_bf16 v90, s3, v69
    v_dot2c_f32_bf16 v91, v69, v69
    v_dot2c_f32_bf16 v88, s3, v42
    v_dot2c_f32_bf16 v89, v42, v42
    v_dot2c_f32_bf16 v90, s3, v70
    v_dot2c_f32_bf16 v91, v70, v70
    v_dot2c_f32_bf16 v88, s3, v43
    v_dot2c_f32_bf16 v89, v43, v43
    v_dot2c_f32_bf16 v90, s3, v71
    v_dot2c_f32_bf16 v91, v71, v71
    v_lshlrev_b32 v108, 16, v16
    v_and_b32 v109, 0xffff0000, v16
    v_lshlrev_b32 v110, 16, v17
    v_add_f32_dpp v88, v88, v88 quad_perm:[1,0,3,2] row_mask:0xf bank_mask:0xf
    v_add_f32_dpp v89, v89, v89 quad_perm:[1,0,3,2] row_mask:0xf bank_mask:0xf
    v_add_f32_dpp v90, v90, v90 quad_perm:[1,0,3,2] row_mask:0xf bank_mask:0xf
    v_add_f32_dpp v91, v91, v91 quad_perm:[1,0,3,2] row_mask:0xf bank_mask:0xf
    v_add_f32_dpp v88, v88, v88 quad_perm:[2,3,0,1] row_mask:0xf bank_mask:0xf
    v_add_f32_dpp v89, v89, v89 quad_perm:[2,3,0,1] row_mask:0xf bank_mask:0xf
    v_add_f32_dpp v90, v90, v90 quad_perm:[2,3,0,1] row_mask:0xf bank_mask:0xf
    v_add_f32_dpp v91, v91, v91 quad_perm:[2,3,0,1] row_mask:0xf bank_mask:0xf
    v_add_f32_dpp v88, v88, v88 row_half_mirror row_mask:0xf bank_mask:0xf
    v_add_f32_dpp v89, v89, v89 row_half_mirror row_mask:0xf bank_mask:0xf
    v_add_f32_dpp v90, v90, v90 row_half_mirror row_mask:0xf bank_mask:0xf
    v_add_f32_dpp v91, v91, v91 row_half_mirror row_mask:0xf bank_mask:0xf
    v_mul_f32 v88, 0x3b124925, v88
    v_mul_f32 v90, 0x3b124925, v90
    v_mov_b32 v92, 0x3b124925
    v_fmaak_f32 v89, v92, v89, 0x3727c5ac
    v_fmaak_f32 v91, v92, v91, 0x3727c5ac
    v_fma_f32 v89, -v88, v88, v89
    v_fma_f32 v91, -v90, v90, v91
    v_max_f32 v89, 0x3727c5ac, v89
    v_max_f32 v91, 0x3727c5ac, v91
    v_rsq_f32 v89, v89
    v_rsq_f32 v91, v91
    v_and_b32 v111, 0xffff0000, v17
    v_lshlrev_b32 v112, 16, v18
    v_and_b32 v113, 0xffff0000, v18
    v_lshlrev_b32 v114, 16, v19
    v_and_b32 v115, 0xffff0000, v19
    v_lshlrev_b32 v116, 16, v44
    v_and_b32 v117, 0xffff0000, v44
    v_lshlrev_b32 v118, 16, v45
    v_and_b32 v119, 0xffff0000, v45
    v_lshlrev_b32 v120, 16, v46
    v_and_b32 v121, 0xffff0000, v46
    v_lshlrev_b32 v122, 16, v47
    v_and_b32 v123, 0xffff0000, v47
    v_mul_f32 v88, v88, v89
    v_mul_f32 v90, v90, v91
    v_pk_fma_f32 v[108:109], v[108:109], v[88:89], v[88:89] op_sel:[0,1,0] op_sel_hi:[1,1,0] neg_lo:[0,0,1] neg_hi:[0,0,1]
    v_pk_fma_f32 v[110:111], v[110:111], v[88:89], v[88:89] op_sel:[0,1,0] op_sel_hi:[1,1,0] neg_lo:[0,0,1] neg_hi:[0,0,1]
    v_pk_fma_f32 v[112:113], v[112:113], v[88:89], v[88:89] op_sel:[0,1,0] op_sel_hi:[1,1,0] neg_lo:[0,0,1] neg_hi:[0,0,1]
    v_pk_fma_f32 v[114:115], v[114:115], v[88:89], v[88:89] op_sel:[0,1,0] op_sel_hi:[1,1,0] neg_lo:[0,0,1] neg_hi:[0,0,1]
    v_cvt_pk_f16_f32 v16, v108, v109
    v_cvt_pk_f16_f32 v17, v110, v111
    v_cvt_pk_f16_f32 v18, v112, v113
    v_cvt_pk_f16_f32 v19, v114, v115
    ds_write_b128 v100, v[16:19]
    v_pk_fma_f32 v[116:117], v[116:117], v[90:91], v[90:91] op_sel:[0,1,0] op_sel_hi:[1,1,0] neg_lo:[0,0,1] neg_hi:[0,0,1]
    v_pk_fma_f32 v[118:119], v[118:119], v[90:91], v[90:91] op_sel:[0,1,0] op_sel_hi:[1,1,0] neg_lo:[0,0,1] neg_hi:[0,0,1]
    v_pk_fma_f32 v[120:121], v[120:121], v[90:91], v[90:91] op_sel:[0,1,0] op_sel_hi:[1,1,0] neg_lo:[0,0,1] neg_hi:[0,0,1]
    v_pk_fma_f32 v[122:123], v[122:123], v[90:91], v[90:91] op_sel:[0,1,0] op_sel_hi:[1,1,0] neg_lo:[0,0,1] neg_hi:[0,0,1]
    v_cvt_pk_f16_f32 v20, v116, v117
    v_cvt_pk_f16_f32 v21, v118, v119
    v_cvt_pk_f16_f32 v22, v120, v121
    v_cvt_pk_f16_f32 v23, v122, v123
    ds_write_b128 v100, v[20:23] offset:512
    s_and_b32 s3, s30, 1
    s_lshl_b32 s3, s3, 2
    s_lshr_b32 s40, s28, 1
    s_and_b32 s40, s40, 7
    s_xor_b32 s3, s3, s40
    v_xor_b32 v97, s3, v4
    v_xor_b32 v97, v97, v8
    s_lshr_b32 s3, s30, 1
    s_lshl_b32 s3, s3, 12
    v_lshl_add_u32 v96, v3, 7, s3
    v_lshl_add_u32 v102, v97, 4, v96
    v_xor_b32 v103, 32, v102
    s_waitcnt lgkmcnt(0)
    s_barrier
    ds_read_b64_tr_b16 v[24:25], v101
    ds_read_b64_tr_b16 v[26:27], v101 offset:512
    ds_read_b64_tr_b16 v[28:29], v101 offset:1024
    ds_read_b64_tr_b16 v[30:31], v101 offset:1536
    ds_read_b64_tr_b16 v[32:33], v101 offset:2048
    ds_read_b64_tr_b16 v[34:35], v101 offset:2560
    ds_read_b64_tr_b16 v[36:37], v101 offset:3072
    ds_read_b64_tr_b16 v[38:39], v101 offset:3584
    v_lshrrev_b32 v96, 3, v0
    v_and_b32 v97, 7, v96
    v_xor_b32 v97, v97, v8
    v_lshlrev_b32 v97, 4, v97
    v_lshl_add_u32 v104, v96, 7, v97
    v_mul_u32_u24 v96, 57344, v96
    v_lshl_add_u32 v105, v8, 4, v96
    s_lshl_b32 s3, s29, 13
    s_lshl_b32 s43, s28, 7
    s_add_u32 s43, s43, s3
    s_add_u32 s48, s43, 4096
    s_waitcnt lgkmcnt(6)
    v_mfma_f32_32x32x16_f16 v[108:123], v[24:27], v[72:75], 0
    v_cmp_eq_u32 vcc, 0, v1
    v_mov_b32 v92, 0x7ffffffc
    s_lshr_b32 s3, s28, 1
    s_lshl_b32 s3, s3, 6
    v_cndmask_b32 v13, v92, 0, vcc
    v_lshlrev_b32 v107, 2, v95
    s_waitcnt lgkmcnt(4)
    v_mfma_f32_32x32x16_f16 v[108:123], v[28:31], v[76:79], v[108:123]
    buffer_load_dword v9, v107, s[24:27], 0 offen sc1
    s_and_b32 s40, s28, 1
    s_mul_i32 s40, s40, 28
    s_add_u32 s3, s3, s40
    s_lshl_b32 s40, s29, 2
    s_waitcnt lgkmcnt(2)
    v_mfma_f32_32x32x16_f16 v[108:123], v[32:35], v[80:83], v[108:123]
    s_add_u32 s3, s3, s40
    s_add_u32 s3, s3, s30
    s_mul_i32 s38, s3, 32
    s_add_u32 s38, s38, 2588672
    buffer_store_dword v15, v13, s[8:11], s38 offen sc1
    s_waitcnt lgkmcnt(0)
    v_mfma_f32_32x32x16_f16 v[108:123], v[36:39], v[84:87], v[108:123]
    s_lshl_b32 s3, s31, 6
    s_lshl_b32 s40, s30, 4
    s_add_u32 s3, s3, s40
    s_add_u32 s3, s3, s32
    s_mul_i32 s39, s3, 128
    s_add_u32 s39, s39, 2719744
    buffer_store_dword v15, v13, s[8:11], s39 offen sc1
    s_nop 4
    v_cvt_pk_bf16_f32 v48, v108, v110
    v_cvt_pk_bf16_f32 v49, v112, v114
    v_cvt_pk_bf16_f32 v50, v116, v118
    v_cvt_pk_bf16_f32 v51, v120, v122
    ds_write_b128 v102, v[48:51] offset:8192
    v_cvt_pk_bf16_f32 v52, v109, v111
    v_cvt_pk_bf16_f32 v53, v113, v115
    v_cvt_pk_bf16_f32 v54, v117, v119
    v_cvt_pk_bf16_f32 v55, v121, v123
    ds_write_b128 v103, v[52:55] offset:8192
    s_sub_u32 s54, 64, s28
    s_cmp_eq_u32 s28, 0
    s_cselect_b32 s54, 32, s54
    s_cmp_ge_u32 s30, 2
    s_cselect_b32 s33, s54, s28
    s_and_b32 s3, s30, 1
    s_mul_i32 s3, s3, 224
    s_lshl_b32 s34, s29, 5
    s_add_u32 s34, s34, s3
    v_lshl_add_u32 v5, v3, 6, s33
    v_lshlrev_b32 v92, 2, v1
    v_add_u32 v92, 161024, v92
    ds_write_b32 v92, v15
    s_waitcnt lgkmcnt(0)
    s_barrier
    ds_read_b128 v[56:59], v104 offset:8192
    ds_read_b128 v[60:63], v104 offset:12288
    s_waitcnt lgkmcnt(1)
    buffer_store_dwordx4 v[56:59], v105, s[8:11], s43 offen sc1
    s_waitcnt lgkmcnt(0)
    buffer_store_dwordx4 v[60:63], v105, s[8:11], s48 offen sc1
    s_lshl_b32 s3, s29, 5
    v_add_u32 v140, s3, v3
    v_mul_u32_u24 v141, 4682, v140
    v_lshrrev_b32 v141, 16, v141
    v_mul_u32_u24 v141, 14, v141
    v_sub_u32 v141, v140, v141
    v_cvt_f32_u32 v140, v140
    v_cvt_f32_u32 v141, v141
    v_mul_f32 v140, 0x3b124925, v140
    v_mul_f32 v141, 0x3d924925, v141
    s_and_b32 s3, s30, 1
    s_mul_i32 s3, s3, 0x3f800000
    v_add_f32 v142, s3, v94
    s_lshr_b32 s3, s30, 1
    s_mul_i32 s3, s3, 0x3e800000
    v_mov_b32 v143, s3
    v_fmac_f32 v143, v142, v140
    s_lshl_b32 s3, 0, 1
    v_cvt_f32_u32 v142, s3
    v_mul_f32 v142, v142, v141
    v_fract_f32 v142, v142
    v_add_f32 v143, v143, v142
    v_cos_f32 v138, v141
    v_fmamk_f32 v144, v140, 0x00000000, v143
    v_fmamk_f32 v145, v140, 0x40000000, v143
    v_fmamk_f32 v146, v140, 0x41000000, v143
    v_fmamk_f32 v147, v140, 0x41200000, v143
    v_fmamk_f32 v148, v140, 0x41800000, v143
    v_fmamk_f32 v149, v140, 0x41900000, v143
    v_fmamk_f32 v150, v140, 0x41c00000, v143
    v_fmamk_f32 v151, v140, 0x41d00000, v143
    v_add_f32 v138, v138, v138
    v_add_f32 v152, v141, v144
    v_add_f32 v153, v141, v145
    v_add_f32 v154, v141, v146
    v_add_f32 v155, v141, v147
    s_add_u32 m0, s42, 73728
    s_mov_b32 s41, 229376
    buffer_load_dwordx4 v11, s[12:15], s41 offen lds
    v_add_f32 v156, v141, v148
    v_add_f32 v157, v141, v149
    v_add_f32 v158, v141, v150
    v_add_f32 v159, v141, v151
    v_mov_b32 v139, v138
    v_cos_f32 v144, v144
    v_cos_f32 v145, v145
    v_cos_f32 v146, v146
    v_cos_f32 v147, v147
    v_cos_f32 v148, v148
    v_cos_f32 v149, v149
    v_cos_f32 v150, v150
    v_cos_f32 v151, v151
    v_cos_f32 v152, v152
    v_cos_f32 v153, v153
    v_cos_f32 v154, v154
    s_add_u32 m0, s42, 77824
    s_mov_b32 s41, 286720
    buffer_load_dwordx4 v11, s[12:15], s41 offen lds
    v_cos_f32 v155, v155
    v_cos_f32 v156, v156
    v_cos_f32 v157, v157
    v_cos_f32 v158, v158
    v_cos_f32 v159, v159
    v_pk_fma_f32 v[160:161], v[152:153], v[138:139], v[144:145] neg_lo:[0,0,1] neg_hi:[0,0,1]
    v_pk_fma_f32 v[162:163], v[154:155], v[138:139], v[146:147] neg_lo:[0,0,1] neg_hi:[0,0,1]
    v_pk_fma_f32 v[164:165], v[156:157], v[138:139], v[148:149] neg_lo:[0,0,1] neg_hi:[0,0,1]
    v_pk_fma_f32 v[166:167], v[158:159], v[138:139], v[150:151] neg_lo:[0,0,1] neg_hi:[0,0,1]
    v_pk_fma_f32 v[168:169], v[160:161], v[138:139], v[152:153] neg_lo:[0,0,1] neg_hi:[0,0,1]
    v_pk_fma_f32 v[170:171], v[162:163], v[138:139], v[154:155] neg_lo:[0,0,1] neg_hi:[0,0,1]
    v_pk_fma_f32 v[172:173], v[164:165], v[138:139], v[156:157] neg_lo:[0,0,1] neg_hi:[0,0,1]
    v_pk_fma_f32 v[174:175], v[166:167], v[138:139], v[158:159] neg_lo:[0,0,1] neg_hi:[0,0,1]
    v_pk_fma_f32 v[176:177], v[168:169], v[138:139], v[160:161] neg_lo:[0,0,1] neg_hi:[0,0,1]
    v_pk_fma_f32 v[178:179], v[170:171], v[138:139], v[162:163] neg_lo:[0,0,1] neg_hi:[0,0,1]
    v_pk_fma_f32 v[180:181], v[172:173], v[138:139], v[164:165] neg_lo:[0,0,1] neg_hi:[0,0,1]
    s_add_u32 m0, s42, 81920
    s_mov_b32 s41, 344064
    buffer_load_dwordx4 v11, s[12:15], s41 offen lds
    v_pk_fma_f32 v[182:183], v[174:175], v[138:139], v[166:167] neg_lo:[0,0,1] neg_hi:[0,0,1]
    v_pk_fma_f32 v[184:185], v[176:177], v[138:139], v[168:169] neg_lo:[0,0,1] neg_hi:[0,0,1]
    v_pk_fma_f32 v[186:187], v[178:179], v[138:139], v[170:171] neg_lo:[0,0,1] neg_hi:[0,0,1]
    v_pk_fma_f32 v[188:189], v[180:181], v[138:139], v[172:173] neg_lo:[0,0,1] neg_hi:[0,0,1]
    v_pk_fma_f32 v[190:191], v[182:183], v[138:139], v[174:175] neg_lo:[0,0,1] neg_hi:[0,0,1]
    v_pk_fma_f32 v[192:193], v[184:185], v[138:139], v[176:177] neg_lo:[0,0,1] neg_hi:[0,0,1]
    v_pk_fma_f32 v[194:195], v[186:187], v[138:139], v[178:179] neg_lo:[0,0,1] neg_hi:[0,0,1]
    v_pk_fma_f32 v[196:197], v[188:189], v[138:139], v[180:181] neg_lo:[0,0,1] neg_hi:[0,0,1]
    v_pk_fma_f32 v[198:199], v[190:191], v[138:139], v[182:183] neg_lo:[0,0,1] neg_hi:[0,0,1]
    v_pk_fma_f32 v[200:201], v[192:193], v[138:139], v[184:185] neg_lo:[0,0,1] neg_hi:[0,0,1]
    v_pk_fma_f32 v[202:203], v[194:195], v[138:139], v[186:187] neg_lo:[0,0,1] neg_hi:[0,0,1]
    v_pk_fma_f32 v[204:205], v[196:197], v[138:139], v[188:189] neg_lo:[0,0,1] neg_hi:[0,0,1]
    v_pk_fma_f32 v[206:207], v[198:199], v[138:139], v[190:191] neg_lo:[0,0,1] neg_hi:[0,0,1]
    v_pk_fma_f32 v[208:209], v[200:201], v[138:139], v[192:193] neg_lo:[0,0,1] neg_hi:[0,0,1]
    v_pk_fma_f32 v[210:211], v[202:203], v[138:139], v[194:195] neg_lo:[0,0,1] neg_hi:[0,0,1]
    v_pk_fma_f32 v[212:213], v[204:205], v[138:139], v[196:197] neg_lo:[0,0,1] neg_hi:[0,0,1]
    s_add_u32 m0, s42, 86016
    s_mov_b32 s41, 401408
    buffer_load_dwordx4 v11, s[12:15], s41 offen lds
    v_pk_fma_f32 v[214:215], v[206:207], v[138:139], v[198:199] neg_lo:[0,0,1] neg_hi:[0,0,1]
    v_pk_fma_f32 v[216:217], v[208:209], v[138:139], v[200:201] neg_lo:[0,0,1] neg_hi:[0,0,1]
    v_pk_fma_f32 v[218:219], v[210:211], v[138:139], v[202:203] neg_lo:[0,0,1] neg_hi:[0,0,1]
    v_pk_fma_f32 v[220:221], v[212:213], v[138:139], v[204:205] neg_lo:[0,0,1] neg_hi:[0,0,1]
    v_pk_fma_f32 v[222:223], v[214:215], v[138:139], v[206:207] neg_lo:[0,0,1] neg_hi:[0,0,1]
    v_pk_fma_f32 v[224:225], v[216:217], v[138:139], v[208:209] neg_lo:[0,0,1] neg_hi:[0,0,1]
    v_pk_fma_f32 v[226:227], v[218:219], v[138:139], v[210:211] neg_lo:[0,0,1] neg_hi:[0,0,1]
    v_pk_fma_f32 v[228:229], v[220:221], v[138:139], v[212:213] neg_lo:[0,0,1] neg_hi:[0,0,1]
    v_pk_fma_f32 v[230:231], v[222:223], v[138:139], v[214:215] neg_lo:[0,0,1] neg_hi:[0,0,1]
    v_pk_fma_f32 v[232:233], v[224:225], v[138:139], v[216:217] neg_lo:[0,0,1] neg_hi:[0,0,1]
    v_pk_fma_f32 v[234:235], v[226:227], v[138:139], v[218:219] neg_lo:[0,0,1] neg_hi:[0,0,1]
    v_pk_fma_f32 v[236:237], v[228:229], v[138:139], v[220:221] neg_lo:[0,0,1] neg_hi:[0,0,1]
    v_pk_fma_f32 v[238:239], v[230:231], v[138:139], v[222:223] neg_lo:[0,0,1] neg_hi:[0,0,1]
    v_pk_fma_f32 v[240:241], v[232:233], v[138:139], v[224:225] neg_lo:[0,0,1] neg_hi:[0,0,1]
    v_pk_fma_f32 v[242:243], v[234:235], v[138:139], v[226:227] neg_lo:[0,0,1] neg_hi:[0,0,1]
    v_pk_fma_f32 v[244:245], v[236:237], v[138:139], v[228:229] neg_lo:[0,0,1] neg_hi:[0,0,1]
    s_add_u32 m0, s42, 90112
    s_mov_b32 s41, 458752
    buffer_load_dwordx4 v11, s[12:15], s41 offen lds
    v_pk_fma_f32 v[246:247], v[238:239], v[138:139], v[230:231] neg_lo:[0,0,1] neg_hi:[0,0,1]
    v_pk_fma_f32 v[248:249], v[240:241], v[138:139], v[232:233] neg_lo:[0,0,1] neg_hi:[0,0,1]
    v_pk_fma_f32 v[250:251], v[242:243], v[138:139], v[234:235] neg_lo:[0,0,1] neg_hi:[0,0,1]
    v_pk_fma_f32 v[252:253], v[244:245], v[138:139], v[236:237] neg_lo:[0,0,1] neg_hi:[0,0,1]
    v_pk_fma_f32 v[254:255], v[246:247], v[138:139], v[238:239] neg_lo:[0,0,1] neg_hi:[0,0,1]
    v_cvt_f32_u32 v108, v5
    v_mul_f32 v108, 0x3a000000, v108
    v_mul_f32 v109, v94, v108
    v_mul_f32 v110, 0x41000000, v108
    v_cos_f32 v110, v110
    v_fmamk_f32 v32, v108, 0x00000000, v109
    v_fmamk_f32 v33, v108, 0x3f800000, v109
    v_fmamk_f32 v34, v108, 0x40000000, v109
    v_fmamk_f32 v35, v108, 0x40400000, v109
    v_fmamk_f32 v36, v108, 0x41000000, v109
    v_fmamk_f32 v37, v108, 0x41100000, v109
    s_add_u32 m0, s42, 94208
    s_mov_b32 s41, 516096
    buffer_load_dwordx4 v11, s[12:15], s41 offen lds
    v_fmamk_f32 v38, v108, 0x41200000, v109
    v_fmamk_f32 v39, v108, 0x41300000, v109
    v_add_f32 v110, v110, v110
    v_cos_f32 v16, v32
    s_waitcnt vmcnt(10)
    v_cmp_gt_u32 vcc, 1, v9
    s_nop 0
    s_cbranch_vccz CHK1
    s_mov_b32 s55, 0
POLL2:
    buffer_load_dword v9, v107, s[24:27], 0 offen sc1
    s_add_u32 s55, s55, 1
    s_waitcnt vmcnt(0)
    v_cmp_gt_u32 vcc, 1, v9
    s_nop 0
    s_cbranch_vccz POLL2D
    s_cmp_lt_u32 s55, 20000
    s_cbranch_scc1 POLL2
POLL2D:
CHK1:
    s_mul_i32 s40, s2, 32
    s_add_u32 s40, s40, 2571264
    v_mov_b32 v92, 1
    v_cmp_eq_u32 vcc, 0, v0
    v_mov_b32 v93, 0x7ffffffc
    s_nop 0
    v_cndmask_b32 v93, v93, 0, vcc
    s_waitcnt vmcnt(6)
    s_barrier
    buffer_store_dword v92, v93, s[8:11], s40 offen sc1
    s_and_b32 s3, s30, 1
    s_lshl_b32 s3, s3, 7
    s_add_u32 s52, s3, 2580480
    s_lshl_b32 s3, 0, 8
    s_add_u32 s52, s52, s3
    s_lshl_b32 s49, s34, 2
    s_add_u32 s49, s49, 2543104
    v_xor_b32 v64, 1, v4
    v_mul_u32_u24 v64, 3584, v64
    v_lshl_add_u32 v64, v3, 2, v64
    v_mul_u32_u24 v65, 3584, v4
    v_lshl_add_u32 v65, v3, 2, v65
    s_cmp_eq_u32 s33, 0
    s_cselect_b32 s51, 0, 1
    v_and_b32 v70, s51, v4
    v_lshrrev_b32 v8, 2, v1
    v_mul_u32_u24 v8, 57344, v8
    v_lshrrev_b32 v15, 4, v1
    v_xor_b32 v15, v15, v1
    v_and_b32 v15, 3, v15
    v_lshl_add_u32 v8, v15, 4, v8
    s_mul_i32 s3, s33, 896
    s_lshl_b32 s40, s34, 1
    s_add_u32 s3, s3, s40
    s_lshl_b32 m0, s30, 12
    s_add_u32 s40, s3, 916480
    buffer_load_dwordx4 v8, s[4:7], s3 offen lds
    buffer_load_dwordx4 v8, s[4:7], s40 offen offset:1024 lds
    v_cos_f32 v17, v33
    v_cos_f32 v18, v34
    v_cos_f32 v19, v35
    v_cos_f32 v20, v36
    v_cos_f32 v21, v37
    v_cos_f32 v22, v38
    v_cos_f32 v23, v39
    v_mov_b32 v111, v110
    s_add_u32 m0, s42, 98304
    s_mov_b32 s41, 573440
    buffer_load_dwordx4 v11, s[12:15], s41 offen lds
    v_sin_f32 v32, v32
    v_sin_f32 v33, v33
    v_sin_f32 v34, v34
    v_sin_f32 v35, v35
    v_sin_f32 v36, v36
    v_sin_f32 v37, v37
    v_sin_f32 v38, v38
    v_sin_f32 v39, v39
    s_add_u32 m0, s42, 102400
    s_mov_b32 s41, 630784
    buffer_load_dwordx4 v11, s[12:15], s41 offen lds
    v_pk_fma_f32 v[24:25], v[20:21], v[110:111], v[16:17] neg_lo:[0,0,1] neg_hi:[0,0,1]
    v_pk_fma_f32 v[26:27], v[22:23], v[110:111], v[18:19] neg_lo:[0,0,1] neg_hi:[0,0,1]
    v_pk_fma_f32 v[40:41], v[36:37], v[110:111], v[32:33] neg_lo:[0,0,1] neg_hi:[0,0,1]
    v_pk_fma_f32 v[42:43], v[38:39], v[110:111], v[34:35] neg_lo:[0,0,1] neg_hi:[0,0,1]
    v_pk_fma_f32 v[28:29], v[24:25], v[110:111], v[20:21] neg_lo:[0,0,1] neg_hi:[0,0,1]
    v_pk_fma_f32 v[30:31], v[26:27], v[110:111], v[22:23] neg_lo:[0,0,1] neg_hi:[0,0,1]
    v_pk_fma_f32 v[44:45], v[40:41], v[110:111], v[36:37] neg_lo:[0,0,1] neg_hi:[0,0,1]
    v_pk_fma_f32 v[46:47], v[42:43], v[110:111], v[38:39] neg_lo:[0,0,1] neg_hi:[0,0,1]
    s_add_u32 m0, s42, 106496
    s_mov_b32 s41, 688128
    buffer_load_dwordx4 v11, s[12:15], s41 offen lds
    v_cvt_pk_bf16_f32 v72, v16, v17
    v_cvt_pk_bf16_f32 v73, v18, v19
    v_cvt_pk_bf16_f32 v74, v20, v21
    v_cvt_pk_bf16_f32 v75, v22, v23
    v_cvt_pk_bf16_f32 v76, v24, v25
    v_cvt_pk_bf16_f32 v77, v26, v27
    v_cvt_pk_bf16_f32 v78, v28, v29
    v_cvt_pk_bf16_f32 v79, v30, v31
    s_add_u32 m0, s42, 110592
    s_mov_b32 s41, 745472
    buffer_load_dwordx4 v11, s[12:15], s41 offen lds
    buffer_load_dword v128, v64, s[8:11], s52 offen sc1
    buffer_load_dword v129, v64, s[8:11], s52 offen offset:256 sc1
    buffer_load_dword v130, v64, s[8:11], s52 offen offset:512 sc1
    buffer_load_dword v131, v64, s[8:11], s52 offen offset:768 sc1
    buffer_load_dword v132, v64, s[8:11], s52 offen offset:1024 sc1
    buffer_load_dword v133, v64, s[8:11], s52 offen offset:1280 sc1
    buffer_load_dword v134, v64, s[8:11], s52 offen offset:1536 sc1
    buffer_load_dword v135, v65, s[8:11], s49 offen sc1
    v_cvt_pk_bf16_f32 v80, v32, v33
    v_cvt_pk_bf16_f32 v81, v34, v35
    v_cvt_pk_bf16_f32 v82, v36, v37
    v_cvt_pk_bf16_f32 v83, v38, v39
    v_cvt_pk_bf16_f32 v84, v40, v41
    v_cvt_pk_bf16_f32 v85, v42, v43
    v_cvt_pk_bf16_f32 v86, v44, v45
    v_cvt_pk_bf16_f32 v87, v46, v47
    s_add_u32 m0, s42, 114688
    s_mov_b32 s41, 802816
    buffer_load_dwordx4 v11, s[12:15], s41 offen lds
    v_bfe_u32 v98, v1, 2, 2
    v_xor_b32 v99, s30, v98
    v_lshlrev_b32 v12, 6, v99
    v_lshl_add_u32 v12, v98, 8, v12
    v_lshl_add_u32 v12, v4, 10, v12
    v_bfe_u32 v98, v1, 4, 1
    v_lshl_add_u32 v12, v98, 5, v12
    v_lshl_add_u32 v12, v95, 3, v12
    s_add_u32 m0, s42, 118784
    s_mov_b32 s41, 860160
    buffer_load_dwordx4 v11, s[12:15], s41 offen lds
    v_add_u32 v14, 81920, v12
    v_add_u32 v10, 147456, v12
    v_add_u32 v12, 16384, v12
    s_and_b32 s3, s30, 1
    s_lshl_b32 s3, s3, 1
    v_bfe_u32 v6, v1, 1, 3
    v_xor_b32 v6, v6, v4
    v_xor_b32 v6, s3, v6
    s_add_u32 m0, s42, 122880
    s_mov_b32 s41, 917504
    buffer_load_dwordx4 v11, s[12:15], s41 offen lds
    v_xor_b32 v7, 4, v6
    v_lshlrev_b32 v8, 7, v3
    v_add_u32 v8, 16384, v8
    v_lshl_add_u32 v6, v6, 4, v8
    v_lshl_add_u32 v7, v7, 4, v8
    s_mul_i32 s46, s28, 57344
    s_lshl_b32 s47, s30, 11
    s_add_u32 s46, s46, s47
    s_add_u32 m0, s42, 126976
    s_mov_b32 s41, 974848
    buffer_load_dwordx4 v11, s[12:15], s41 offen lds
    s_add_u32 s47, s47, 16384
    s_add_u32 s45, s46, 57344
    s_mov_b32 s44, s46
    s_lshl_b32 s53, 0, 13
    s_add_u32 s46, s46, s53
    s_lshl_b32 s53, s30, 12
    v_mul_u32_u24 v68, 0x3f80, v4
    v_xor_b32 v66, 0x3f80, v68
    s_add_u32 m0, s42, 131072
    s_mov_b32 s41, 1032192
    buffer_load_dwordx4 v11, s[12:15], s41 offen lds
    v_lshlrev_b32 v69, 16, v68
    v_lshlrev_b32 v67, 16, v66
    v_accvgpr_write_b32 a224, 0
    v_accvgpr_write_b32 a225, 0
    v_accvgpr_write_b32 a227, 0
    v_accvgpr_write_b32 a228, 0
    v_accvgpr_write_b32 a229, 0
    v_accvgpr_write_b32 a231, 0
    s_add_u32 m0, s42, 135168
    s_mov_b32 s41, 1089536
    buffer_load_dwordx4 v11, s[12:15], s41 offen lds
    v_accvgpr_write_b32 a232, 0
    v_accvgpr_write_b32 a233, 0
    v_accvgpr_write_b32 a234, 0
    v_accvgpr_write_b32 a236, 0
    v_accvgpr_write_b32 a237, 0
    v_accvgpr_write_b32 a238, 0
    v_accvgpr_write_b32 a240, 0
    v_accvgpr_write_b32 a241, 0
    s_add_u32 m0, s42, 139264
    s_mov_b32 s41, 1146880
    buffer_load_dwordx4 v11, s[12:15], s41 offen lds
    v_accvgpr_write_b32 a226, v66
    v_accvgpr_write_b32 a230, v67
    v_accvgpr_write_b32 a235, v66
    v_accvgpr_write_b32 a239, v67
    s_cmp_eq_u32 s28, 0
    s_cbranch_scc1 M_T0
    s_cmp_ge_u32 s30, 2
    s_cselect_b32 s3, 0x80008000, 0
    s_cselect_b32 s40, 0, 0x80008000
    v_xor_b32 v88, s3, v80
    v_xor_b32 v96, s40, v72
    v_xor_b32 v89, s3, v81
    v_xor_b32 v97, s40, v73
    v_xor_b32 v90, s3, v82
    v_xor_b32 v98, s40, v74
    v_xor_b32 v91, s3, v83
    v_xor_b32 v99, s40, v75
    v_xor_b32 v92, s3, v84
    v_xor_b32 v100, s40, v76
    v_xor_b32 v93, s3, v85
    v_xor_b32 v101, s40, v77
    v_xor_b32 v94, s3, v86
    v_xor_b32 v102, s40, v78
    v_xor_b32 v95, s3, v87
    v_xor_b32 v103, s40, v79
    s_branch M_T1
M_T0:
    s_cmp_ge_u32 s30, 2
    s_cselect_b32 s3, -1, 0
    s_cselect_b32 s40, 0, -1
    v_and_b32 v88, s3, v72
    v_and_b32 v96, s3, v80
    v_and_b32 v72, s40, v72
    v_and_b32 v80, s40, v80
    v_and_b32 v89, s3, v73
    v_and_b32 v97, s3, v81
    v_and_b32 v73, s40, v73
    v_and_b32 v81, s40, v81
    v_and_b32 v90, s3, v74
    v_and_b32 v98, s3, v82
    v_and_b32 v74, s40, v74
    v_and_b32 v82, s40, v82
    v_and_b32 v91, s3, v75
    v_and_b32 v99, s3, v83
    v_and_b32 v75, s40, v75
    v_and_b32 v83, s40, v83
    v_and_b32 v92, s3, v76
    v_and_b32 v100, s3, v84
    v_and_b32 v76, s40, v76
    v_and_b32 v84, s40, v84
    v_and_b32 v93, s3, v77
    v_and_b32 v101, s3, v85
    v_and_b32 v77, s40, v77
    v_and_b32 v85, s40, v85
    v_and_b32 v94, s3, v78
    v_and_b32 v102, s3, v86
    v_and_b32 v78, s40, v78
    v_and_b32 v86, s40, v86
    v_and_b32 v95, s3, v79
    v_and_b32 v103, s3, v87
    v_and_b32 v79, s40, v79
    v_and_b32 v87, s40, v87
M_T1:
    s_mov_b32 s50, 2571264
    v_or_b32 v9, 32, v0
    v_cmp_gt_u32 vcc, 64, v0
    s_nop 1
    v_cndmask_b32 v9, v0, v9, vcc
    v_mul_u32_u24 v9, 32, v9
    s_mov_b32 s55, 0
    s_mov_b32 s40, 0x07060302
M_MODL:
    s_waitcnt vmcnt(12)
    v_min3_u32 v71, v128, v129, v130
    s_waitcnt vmcnt(10)
    v_min3_u32 v71, v71, v131, v132
    s_waitcnt vmcnt(8)
    v_min3_u32 v71, v71, v133, v134
    v_or_b32 v71, v70, v71
    s_waitcnt vmcnt(7)
    v_min_u32 v71, v71, v135
    v_cmp_eq_u32 vcc, 0, v71
    s_nop 0
    s_cbranch_vccz M_MODD
    s_add_u32 s55, s55, 1
    s_cmp_ge_u32 s55, 20000
    s_cbranch_scc1 M_MODD
    s_sleep 6
    buffer_load_dword v128, v64, s[8:11], s52 offen sc1
    buffer_load_dword v129, v64, s[8:11], s52 offen offset:256 sc1
    buffer_load_dword v130, v64, s[8:11], s52 offen offset:512 sc1
    buffer_load_dword v131, v64, s[8:11], s52 offen offset:768 sc1
    buffer_load_dword v132, v64, s[8:11], s52 offen offset:1024 sc1
    buffer_load_dword v133, v64, s[8:11], s52 offen offset:1280 sc1
    buffer_load_dword v134, v64, s[8:11], s52 offen offset:1536 sc1
    buffer_load_dword v135, v65, s[8:11], s49 offen sc1
    s_waitcnt vmcnt(0)
    s_branch M_MODL
M_MODD:
    v_perm_b32 v136, v129, v128, s40
    v_perm_b32 v137, v131, v130, s40
    v_perm_b32 v138, v133, v132, s40
    v_perm_b32 v139, v135, v134, s40
    v_mov_b32 v140, v69
    s_cmp_lg_u32 s33, 0
    s_cbranch_scc1 M_NODC1
    v_accvgpr_write_b32 a226, v68
    v_accvgpr_write_b32 a230, v69
    v_accvgpr_write_b32 a235, v68
    v_accvgpr_write_b32 a239, v69
    v_mfma_f32_32x32x16_bf16 v[104:119], v[136:139], a[226:229], 0
    v_mfma_f32_32x32x16_bf16 v[120:135], v[136:139], a[230:233], 0
    s_nop 10
    v_pk_mul_f32 v[16:17], v[144:145], v[104:105]
    v_pk_mul_f32 v[18:19], v[146:147], v[106:107]
    v_pk_mul_f32 v[20:21], v[148:149], v[108:109]
    v_pk_mul_f32 v[22:23], v[150:151], v[110:111]
    v_pk_mul_f32 v[24:25], v[152:153], v[112:113]
    v_pk_mul_f32 v[26:27], v[154:155], v[114:115]
    v_pk_mul_f32 v[28:29], v[156:157], v[116:117]
    v_pk_mul_f32 v[30:31], v[158:159], v[118:119]
    v_mfma_f32_32x32x16_bf16 v[104:119], v[136:139], a[234:237], 0
    v_pk_fma_f32 v[16:17], v[160:161], v[120:121], v[16:17]
    v_pk_fma_f32 v[18:19], v[162:163], v[122:123], v[18:19]
    v_pk_fma_f32 v[20:21], v[164:165], v[124:125], v[20:21]
    v_pk_fma_f32 v[22:23], v[166:167], v[126:127], v[22:23]
    v_pk_fma_f32 v[24:25], v[168:169], v[128:129], v[24:25]
    v_pk_fma_f32 v[26:27], v[170:171], v[130:131], v[26:27]
    v_pk_fma_f32 v[28:29], v[172:173], v[132:133], v[28:29]
    v_pk_fma_f32 v[30:31], v[174:175], v[134:135], v[30:31]
    v_mfma_f32_32x32x16_bf16 v[120:135], v[136:139], a[238:241], 0
    s_nop 2
    v_pk_fma_f32 v[16:17], v[176:177], v[104:105], v[16:17]
    v_pk_fma_f32 v[18:19], v[178:179], v[106:107], v[18:19]
    v_pk_fma_f32 v[20:21], v[180:181], v[108:109], v[20:21]
    v_pk_fma_f32 v[22:23], v[182:183], v[110:111], v[22:23]
    v_pk_fma_f32 v[24:25], v[184:185], v[112:113], v[24:25]
    v_pk_fma_f32 v[26:27], v[186:187], v[114:115], v[26:27]
    v_pk_fma_f32 v[28:29], v[188:189], v[116:117], v[28:29]
    v_pk_fma_f32 v[30:31], v[190:191], v[118:119], v[30:31]
    v_mfma_f32_32x32x16_bf16 v[104:119], v[136:139], a[224:227], 0
    v_pk_fma_f32 v[16:17], v[192:193], v[120:121], v[16:17]
    v_pk_fma_f32 v[18:19], v[194:195], v[122:123], v[18:19]
    v_pk_fma_f32 v[20:21], v[196:197], v[124:125], v[20:21]
    v_pk_fma_f32 v[22:23], v[198:199], v[126:127], v[22:23]
    v_pk_fma_f32 v[24:25], v[200:201], v[128:129], v[24:25]
    v_pk_fma_f32 v[26:27], v[202:203], v[130:131], v[26:27]
    v_pk_fma_f32 v[28:29], v[204:205], v[132:133], v[28:29]
    v_pk_fma_f32 v[30:31], v[206:207], v[134:135], v[30:31]
    v_mfma_f32_32x32x16_bf16 v[120:135], v[136:139], a[228:231], 0
    s_nop 2
    v_pk_fma_f32 v[16:17], v[208:209], v[104:105], v[16:17]
    v_pk_fma_f32 v[18:19], v[210:211], v[106:107], v[18:19]
    v_pk_fma_f32 v[20:21], v[212:213], v[108:109], v[20:21]
    v_pk_fma_f32 v[22:23], v[214:215], v[110:111], v[22:23]
    v_pk_fma_f32 v[24:25], v[216:217], v[112:113], v[24:25]
    v_pk_fma_f32 v[26:27], v[218:219], v[114:115], v[26:27]
    v_pk_fma_f32 v[28:29], v[220:221], v[116:117], v[28:29]
    v_pk_fma_f32 v[30:31], v[222:223], v[118:119], v[30:31]
    v_mfma_f32_32x32x16_bf16 v[104:119], v[136:139], a[232:235], 0
    v_pk_fma_f32 v[16:17], v[224:225], v[120:121], v[16:17]
    v_pk_fma_f32 v[18:19], v[226:227], v[122:123], v[18:19]
    v_pk_fma_f32 v[20:21], v[228:229], v[124:125], v[20:21]
    v_pk_fma_f32 v[22:23], v[230:231], v[126:127], v[22:23]
    v_pk_fma_f32 v[24:25], v[232:233], v[128:129], v[24:25]
    v_pk_fma_f32 v[26:27], v[234:235], v[130:131], v[26:27]
    v_pk_fma_f32 v[28:29], v[236:237], v[132:133], v[28:29]
    v_pk_fma_f32 v[30:31], v[238:239], v[134:135], v[30:31]
    s_nop 3
    v_pk_fma_f32 v[16:17], v[240:241], v[104:105], v[16:17]
    v_pk_fma_f32 v[18:19], v[242:243], v[106:107], v[18:19]
    v_pk_fma_f32 v[20:21], v[244:245], v[108:109], v[20:21]
    v_pk_fma_f32 v[22:23], v[246:247], v[110:111], v[22:23]
    v_pk_fma_f32 v[24:25], v[248:249], v[112:113], v[24:25]
    v_pk_fma_f32 v[26:27], v[250:251], v[114:115], v[26:27]
    v_pk_fma_f32 v[28:29], v[252:253], v[116:117], v[28:29]
    v_pk_fma_f32 v[30:31], v[254:255], v[118:119], v[30:31]
    v_accvgpr_write_b32 a226, v66
    v_accvgpr_write_b32 a230, v67
    v_accvgpr_write_b32 a235, v66
    v_accvgpr_write_b32 a239, v67
    v_pk_add_f32 v[16:17], v[16:17], v[24:25]
    v_pk_add_f32 v[18:19], v[18:19], v[26:27]
    v_pk_add_f32 v[20:21], v[20:21], v[28:29]
    v_pk_add_f32 v[22:23], v[22:23], v[30:31]
    v_pk_add_f32 v[16:17], v[16:17], v[20:21]
    v_pk_add_f32 v[18:19], v[18:19], v[22:23]
    v_pk_add_f32 v[16:17], v[16:17], v[18:19]
    v_add_f32 v16, v16, v17
    v_mul_f32 v16, 0x45000000, v16
    v_mov_b32 v17, v16
    s_lshl_b32 s3, s30, 7
    s_add_u32 s3, s3, 160768
    v_permlane32_swap_b32 v16, v17
    v_add_f32 v16, v16, v17
    v_lshl_add_u32 v17, v3, 2, s3
    ds_write_b32 v17, v16
M_NODC1:
    v_mfma_f32_32x32x16_bf16 v[104:119], v[136:139], a[226:229], 0
    v_mfma_f32_32x32x16_bf16 v[120:135], v[136:139], a[230:233], 0
    s_nop 10
    v_pk_mul_f32 v[144:145], v[144:145], v[104:105]
    v_pk_mul_f32 v[146:147], v[146:147], v[106:107]
    v_pk_mul_f32 v[148:149], v[148:149], v[108:109]
    v_pk_mul_f32 v[150:151], v[150:151], v[110:111]
    v_pk_mul_f32 v[152:153], v[152:153], v[112:113]
    v_pk_mul_f32 v[154:155], v[154:155], v[114:115]
    v_pk_mul_f32 v[156:157], v[156:157], v[116:117]
    v_pk_mul_f32 v[158:159], v[158:159], v[118:119]
    v_mfma_f32_32x32x16_bf16 v[104:119], v[136:139], a[234:237], 0
    v_cvt_pk_bf16_f32 v16, v144, v145
    v_cvt_pk_bf16_f32 v17, v146, v147
    v_cvt_pk_bf16_f32 v18, v148, v149
    v_cvt_pk_bf16_f32 v19, v150, v151
    v_cvt_pk_bf16_f32 v20, v152, v153
    v_cvt_pk_bf16_f32 v21, v154, v155
    v_cvt_pk_bf16_f32 v22, v156, v157
    v_cvt_pk_bf16_f32 v23, v158, v159
    v_pk_mul_f32 v[160:161], v[160:161], v[120:121]
    v_pk_mul_f32 v[162:163], v[162:163], v[122:123]
    v_pk_mul_f32 v[164:165], v[164:165], v[124:125]
    v_pk_mul_f32 v[166:167], v[166:167], v[126:127]
    v_pk_mul_f32 v[168:169], v[168:169], v[128:129]
    v_pk_mul_f32 v[170:171], v[170:171], v[130:131]
    v_pk_mul_f32 v[172:173], v[172:173], v[132:133]
    v_pk_mul_f32 v[174:175], v[174:175], v[134:135]
    v_mfma_f32_32x32x16_bf16 v[120:135], v[136:139], a[238:241], 0
    v_cvt_pk_bf16_f32 v24, v160, v161
    v_cvt_pk_bf16_f32 v25, v162, v163
    v_cvt_pk_bf16_f32 v26, v164, v165
    v_cvt_pk_bf16_f32 v27, v166, v167
    v_cvt_pk_bf16_f32 v28, v168, v169
    v_cvt_pk_bf16_f32 v29, v170, v171
    v_cvt_pk_bf16_f32 v30, v172, v173
    v_cvt_pk_bf16_f32 v31, v174, v175
    v_pk_mul_f32 v[176:177], v[176:177], v[104:105]
    v_pk_mul_f32 v[178:179], v[178:179], v[106:107]
    v_pk_mul_f32 v[180:181], v[180:181], v[108:109]
    v_pk_mul_f32 v[182:183], v[182:183], v[110:111]
    v_pk_mul_f32 v[184:185], v[184:185], v[112:113]
    v_pk_mul_f32 v[186:187], v[186:187], v[114:115]
    v_pk_mul_f32 v[188:189], v[188:189], v[116:117]
    v_pk_mul_f32 v[190:191], v[190:191], v[118:119]
    v_mfma_f32_32x32x16_bf16 v[104:119], v[136:139], a[224:227], 0
    v_cvt_pk_bf16_f32 v32, v176, v177
    v_cvt_pk_bf16_f32 v33, v178, v179
    v_cvt_pk_bf16_f32 v34, v180, v181
    v_cvt_pk_bf16_f32 v35, v182, v183
    v_cvt_pk_bf16_f32 v36, v184, v185
    v_cvt_pk_bf16_f32 v37, v186, v187
    v_cvt_pk_bf16_f32 v38, v188, v189
    v_cvt_pk_bf16_f32 v39, v190, v191
    v_pk_mul_f32 v[192:193], v[192:193], v[120:121]
    v_pk_mul_f32 v[194:195], v[194:195], v[122:123]
    v_pk_mul_f32 v[196:197], v[196:197], v[124:125]
    v_pk_mul_f32 v[198:199], v[198:199], v[126:127]
    v_pk_mul_f32 v[200:201], v[200:201], v[128:129]
    v_pk_mul_f32 v[202:203], v[202:203], v[130:131]
    v_pk_mul_f32 v[204:205], v[204:205], v[132:133]
    v_pk_mul_f32 v[206:207], v[206:207], v[134:135]
    v_mfma_f32_32x32x16_bf16 v[120:135], v[136:139], a[228:231], 0
    v_cvt_pk_bf16_f32 v40, v192, v193
    v_cvt_pk_bf16_f32 v41, v194, v195
    v_cvt_pk_bf16_f32 v42, v196, v197
    v_cvt_pk_bf16_f32 v43, v198, v199
    v_cvt_pk_bf16_f32 v44, v200, v201
    v_cvt_pk_bf16_f32 v45, v202, v203
    v_cvt_pk_bf16_f32 v46, v204, v205
    v_cvt_pk_bf16_f32 v47, v206, v207
    s_waitcnt vmcnt(0)
    buffer_load_dword v15, v9, s[8:11], s50 offen sc1
    s_barrier
    ds_read_b64_tr_b16 a[0:1], v12 offset:57344
    ds_read_b64_tr_b16 a[2:3], v12 offset:59392
    ds_read_b64_tr_b16 a[4:5], v12 offset:61440
    ds_read_b64_tr_b16 a[6:7], v12 offset:63488
    ds_read_b64_tr_b16 a[8:9], v14
    ds_read_b64_tr_b16 a[10:11], v14 offset:2048
    ds_read_b64_tr_b16 a[12:13], v14 offset:4096
    ds_read_b64_tr_b16 a[14:15], v14 offset:6144
    ds_read_b64_tr_b16 a[16:17], v14 offset:8192
    ds_read_b64_tr_b16 a[18:19], v14 offset:10240
    ds_read_b64_tr_b16 a[20:21], v14 offset:12288
    ds_read_b64_tr_b16 a[22:23], v14 offset:14336
    ds_read_b64_tr_b16 a[24:25], v14 offset:16384
    ds_read_b64_tr_b16 a[26:27], v14 offset:18432
    ds_read_b64_tr_b16 a[28:29], v14 offset:20480
    ds_read_b64_tr_b16 a[30:31], v14 offset:22528
    ds_read_b64_tr_b16 a[32:33], v14 offset:24576
    ds_read_b64_tr_b16 a[34:35], v14 offset:26624
    ds_read_b64_tr_b16 a[36:37], v14 offset:28672
    ds_read_b64_tr_b16 a[38:39], v14 offset:30720
    ds_read_b64_tr_b16 a[40:41], v14 offset:32768
    ds_read_b64_tr_b16 a[42:43], v14 offset:34816
    ds_read_b64_tr_b16 a[44:45], v14 offset:36864
    ds_read_b64_tr_b16 a[46:47], v14 offset:38912
    ds_read_b64_tr_b16 a[48:49], v14 offset:40960
    ds_read_b64_tr_b16 a[50:51], v14 offset:43008
    ds_read_b64_tr_b16 a[52:53], v14 offset:45056
    ds_read_b64_tr_b16 a[54:55], v14 offset:47104
    ds_read_b64_tr_b16 a[56:57], v14 offset:49152
    ds_read_b64_tr_b16 a[58:59], v14 offset:51200
    ds_read_b64_tr_b16 a[60:61], v14 offset:53248
    ds_read_b64_tr_b16 a[62:63], v14 offset:55296
    ds_read_b64_tr_b16 a[64:65], v14 offset:57344
    ds_read_b64_tr_b16 a[66:67], v14 offset:59392
    ds_read_b64_tr_b16 a[68:69], v14 offset:61440
    ds_read_b64_tr_b16 a[70:71], v14 offset:63488
    ds_read_b64_tr_b16 a[72:73], v10
    ds_read_b64_tr_b16 a[74:75], v10 offset:2048
    ds_read_b64_tr_b16 a[76:77], v10 offset:4096
    ds_read_b64_tr_b16 a[78:79], v10 offset:6144
    ds_read_b64_tr_b16 a[80:81], v10 offset:8192
    ds_read_b64_tr_b16 a[82:83], v10 offset:10240
    s_waitcnt vmcnt(0)
    v_cmp_gt_u32 vcc, 1, v15
    s_nop 0
    s_cbranch_vccz CHK3
    s_mov_b32 s55, 0
POLL4:
    buffer_load_dword v15, v9, s[8:11], s50 offen sc1
    s_add_u32 s55, s55, 1
    s_waitcnt vmcnt(0)
    v_cmp_gt_u32 vcc, 1, v15
    s_nop 0
    s_cbranch_vccz POLL4D
    s_cmp_lt_u32 s55, 20000
    s_cbranch_scc1 POLL4
POLL4D:
CHK3:
    s_waitcnt lgkmcnt(0)
    s_barrier
    s_mov_b32 m0, s47
    s_add_u32 s47, s47, 8192
    buffer_load_dwordx4 v2, s[8:11], s46 offen sc1 lds
    buffer_load_dwordx4 v2, s[8:11], s46 offen offset:1024 sc1 lds
    s_add_u32 s46, s46, 8192
    s_cmp_eq_u32 s46, s45
    s_cselect_b32 s46, s44, s46
    s_mov_b32 m0, s47
    s_add_u32 s47, s47, 8192
    buffer_load_dwordx4 v2, s[8:11], s46 offen sc1 lds
    buffer_load_dwordx4 v2, s[8:11], s46 offen offset:1024 sc1 lds
    s_add_u32 s46, s46, 8192
    s_cmp_eq_u32 s46, s45
    s_cselect_b32 s46, s44, s46
    s_mov_b32 m0, s47
    s_add_u32 s47, s47, 8192
    buffer_load_dwordx4 v2, s[8:11], s46 offen sc1 lds
    buffer_load_dwordx4 v2, s[8:11], s46 offen offset:1024 sc1 lds
    s_add_u32 s46, s46, 8192
    s_cmp_eq_u32 s46, s45
    s_cselect_b32 s46, s44, s46
    s_mov_b32 m0, s47
    s_add_u32 s47, s47, 8192
    buffer_load_dwordx4 v2, s[8:11], s46 offen sc1 lds
    buffer_load_dwordx4 v2, s[8:11], s46 offen offset:1024 sc1 lds
    s_add_u32 s46, s46, 8192
    s_cmp_eq_u32 s46, s45
    s_cselect_b32 s46, s44, s46
    s_mov_b32 m0, s47
    s_add_u32 s47, s47, 8192
    buffer_load_dwordx4 v2, s[8:11], s46 offen sc1 lds
    buffer_load_dwordx4 v2, s[8:11], s46 offen offset:1024 sc1 lds
    s_add_u32 s46, s46, 8192
    s_cmp_eq_u32 s46, s45
    s_cselect_b32 s46, s44, s46
    v_pk_mul_f32 v[208:209], v[208:209], v[104:105]
    v_pk_mul_f32 v[210:211], v[210:211], v[106:107]
    v_pk_mul_f32 v[212:213], v[212:213], v[108:109]
    v_pk_mul_f32 v[214:215], v[214:215], v[110:111]
    v_pk_mul_f32 v[216:217], v[216:217], v[112:113]
    v_pk_mul_f32 v[218:219], v[218:219], v[114:115]
    v_pk_mul_f32 v[220:221], v[220:221], v[116:117]
    v_pk_mul_f32 v[222:223], v[222:223], v[118:119]
    v_mfma_f32_32x32x16_bf16 v[104:119], v[136:139], a[232:235], 0
    v_cvt_pk_bf16_f32 v48, v208, v209
    v_cvt_pk_bf16_f32 v49, v210, v211
    v_cvt_pk_bf16_f32 v50, v212, v213
    v_cvt_pk_bf16_f32 v51, v214, v215
    v_cvt_pk_bf16_f32 v52, v216, v217
    v_cvt_pk_bf16_f32 v53, v218, v219
    v_cvt_pk_bf16_f32 v54, v220, v221
    v_cvt_pk_bf16_f32 v55, v222, v223
    v_pk_mul_f32 v[224:225], v[224:225], v[120:121]
    v_pk_mul_f32 v[226:227], v[226:227], v[122:123]
    v_pk_mul_f32 v[228:229], v[228:229], v[124:125]
    v_pk_mul_f32 v[230:231], v[230:231], v[126:127]
    v_pk_mul_f32 v[232:233], v[232:233], v[128:129]
    v_pk_mul_f32 v[234:235], v[234:235], v[130:131]
    v_pk_mul_f32 v[236:237], v[236:237], v[132:133]
    v_pk_mul_f32 v[238:239], v[238:239], v[134:135]
    v_cvt_pk_bf16_f32 v56, v224, v225
    v_cvt_pk_bf16_f32 v57, v226, v227
    v_cvt_pk_bf16_f32 v58, v228, v229
    v_cvt_pk_bf16_f32 v59, v230, v231
    v_cvt_pk_bf16_f32 v60, v232, v233
    v_cvt_pk_bf16_f32 v61, v234, v235
    v_cvt_pk_bf16_f32 v62, v236, v237
    v_cvt_pk_bf16_f32 v63, v238, v239
    v_pk_mul_f32 v[240:241], v[240:241], v[104:105]
    v_pk_mul_f32 v[242:243], v[242:243], v[106:107]
    v_pk_mul_f32 v[244:245], v[244:245], v[108:109]
    v_pk_mul_f32 v[246:247], v[246:247], v[110:111]
    v_pk_mul_f32 v[248:249], v[248:249], v[112:113]
    v_pk_mul_f32 v[250:251], v[250:251], v[114:115]
    v_pk_mul_f32 v[252:253], v[252:253], v[116:117]
    v_pk_mul_f32 v[254:255], v[254:255], v[118:119]
    v_cvt_pk_bf16_f32 v64, v240, v241
    v_cvt_pk_bf16_f32 v65, v242, v243
    v_cvt_pk_bf16_f32 v66, v244, v245
    v_cvt_pk_bf16_f32 v67, v246, v247
    v_cvt_pk_bf16_f32 v68, v248, v249
    v_cvt_pk_bf16_f32 v69, v250, v251
    v_cvt_pk_bf16_f32 v70, v252, v253
    v_cvt_pk_bf16_f32 v71, v254, v255
    s_mov_b32 m0, s47
    s_add_u32 s47, s47, 8192
    buffer_load_dwordx4 v2, s[8:11], s46 offen sc1 lds
    buffer_load_dwordx4 v2, s[8:11], s46 offen offset:1024 sc1 lds
    s_add_u32 s46, s46, 8192
    s_cmp_eq_u32 s46, s45
    s_cselect_b32 s46, s44, s46
    s_mov_b32 m0, s47
    s_add_u32 s47, s47, 8192
    buffer_load_dwordx4 v2, s[8:11], s46 offen sc1 lds
    buffer_load_dwordx4 v2, s[8:11], s46 offen offset:1024 sc1 lds
    s_add_u32 s46, s46, 8192
    s_cmp_eq_u32 s46, s45
    s_cselect_b32 s46, s44, s46
    s_waitcnt vmcnt(10)
    s_barrier
    ds_read_b128 a[96:99], v6
    ds_read_b128 a[100:103], v6 offset:4096
    ds_read_b128 a[104:107], v7
    ds_read_b128 a[108:111], v7 offset:4096
    s_waitcnt lgkmcnt(3)
    v_mfma_f32_32x32x16_bf16 v[144:159], a[96:99], v[16:19], 0
    ds_read_b128 a[112:115], v6 offset:8192
    v_bfe_u32 v8, v1, 2, 2
    v_xor_b32 v8, v8, v4
    v_lshl_add_u32 v15, v3, 6, s53
    v_lshl_add_u32 v15, v8, 4, v15
    s_waitcnt lgkmcnt(3)
    v_mfma_f32_32x32x16_bf16 v[160:175], a[100:103], v[16:19], 0
    ds_read_b128 a[116:119], v6 offset:12288
    v_xor_b32 v8, 32, v15
    v_add_u32 v9, s53, v2
    ds_read_b128 v[200:203], v15
    ds_read_b128 v[204:207], v8
    s_lshr_b32 s46, s28, 1
    s_waitcnt lgkmcnt(5)
    v_mfma_f32_32x32x16_bf16 v[144:159], a[104:107], v[20:23], v[144:159]
    ds_read_b128 a[120:123], v7 offset:8192
    s_lshl_b32 s46, s46, 2
    s_and_b32 s3, s28, 1
    s_add_u32 s46, s46, s3
    s_and_b32 s3, s30, 2
    s_add_u32 s47, s46, s3
    s_mul_i32 s48, s47, 28672
    s_waitcnt lgkmcnt(5)
    v_mfma_f32_32x32x16_bf16 v[160:175], a[108:111], v[20:23], v[160:175]
    ds_read_b128 a[124:127], v7 offset:12288
    s_lshl_b32 s3, s34, 6
    s_add_u32 s48, s48, s3
    s_add_u32 s48, s48, 2883584
    s_mul_i32 s47, s47, 3584
    s_lshl_b32 s3, s34, 3
    s_add_u32 s47, s47, s3
    s_waitcnt lgkmcnt(5)
    v_mfma_f32_32x32x16_bf16 v[144:159], a[112:115], v[24:27], v[144:159]
    s_waitcnt vmcnt(6)
    s_barrier
    ds_read_b128 a[96:99], v6 offset:16384
    s_add_u32 s47, s47, 2293760
    s_and_b32 s3, s30, 1
    s_lshl_b32 s3, s3, 31
    s_or_b32 s3, s3, 1.0
    s_waitcnt lgkmcnt(5)
    v_mfma_f32_32x32x16_bf16 v[160:175], a[116:119], v[24:27], v[160:175]
    ds_read_b128 a[100:103], v6 offset:20480
    v_lshlrev_b32 v5, 2, v1
    s_waitcnt lgkmcnt(3)
    v_mfma_f32_32x32x16_bf16 v[144:159], a[120:123], v[28:31], v[144:159]
    ds_read_b128 a[104:107], v7 offset:16384
    s_add_u32 m0, s42, 57344
    s_mov_b32 s41, 1204224
    buffer_load_dwordx4 v11, s[12:15], s41 offen lds
    s_waitcnt lgkmcnt(3)
    v_mfma_f32_32x32x16_bf16 v[160:175], a[124:127], v[28:31], v[160:175]
    ds_read_b128 a[108:111], v7 offset:20480
    s_add_u32 m0, s42, 61440
    s_mov_b32 s41, 1261568
    buffer_load_dwordx4 v11, s[12:15], s41 offen lds
    s_waitcnt lgkmcnt(3)
    v_mfma_f32_32x32x16_bf16 v[144:159], a[96:99], v[32:35], v[144:159]
    ds_read_b128 a[112:115], v6 offset:24576
    v_permlane32_swap_b32 v200, v202
    v_permlane32_swap_b32 v201, v203
    v_permlane32_swap_b32 v204, v206
    v_permlane32_swap_b32 v205, v207
    s_waitcnt lgkmcnt(3)
    v_mfma_f32_32x32x16_bf16 v[160:175], a[100:103], v[32:35], v[160:175]
    ds_read_b128 a[116:119], v6 offset:28672
    s_add_u32 m0, s42, 65536
    s_mov_b32 s41, 1318912
    buffer_load_dwordx4 v11, s[12:15], s41 offen lds
    s_waitcnt lgkmcnt(3)
    v_mfma_f32_32x32x16_bf16 v[144:159], a[104:107], v[36:39], v[144:159]
    ds_read_b128 a[120:123], v7 offset:24576
    s_add_u32 m0, s42, 69632
    s_mov_b32 s41, 1376256
    buffer_load_dwordx4 v11, s[12:15], s41 offen lds
    s_waitcnt lgkmcnt(3)
    v_mfma_f32_32x32x16_bf16 v[160:175], a[108:111], v[36:39], v[160:175]
    ds_read_b128 a[124:127], v7 offset:28672
    v_lshlrev_b32 v192, 16, v200
    v_and_b32 v193, 0xffff0000, v200
    v_lshlrev_b32 v194, 16, v201
    v_and_b32 v195, 0xffff0000, v201
    s_waitcnt lgkmcnt(3)
    v_mfma_f32_32x32x16_bf16 v[144:159], a[112:115], v[40:43], v[144:159]
    s_waitcnt vmcnt(6)
    s_barrier
    ds_read_b128 a[96:99], v6 offset:32768
    s_add_u32 m0, s42, 73728
    s_mov_b32 s41, 1433600
    buffer_load_dwordx4 v11, s[12:15], s41 offen lds
    s_waitcnt lgkmcnt(3)
    v_mfma_f32_32x32x16_bf16 v[160:175], a[116:119], v[40:43], v[160:175]
    ds_read_b128 a[100:103], v6 offset:36864
    v_lshlrev_b32 v196, 16, v202
    v_and_b32 v197, 0xffff0000, v202
    v_lshlrev_b32 v198, 16, v203
    v_and_b32 v199, 0xffff0000, v203
    s_waitcnt lgkmcnt(3)
    v_mfma_f32_32x32x16_bf16 v[144:159], a[120:123], v[44:47], v[144:159]
    ds_read_b128 a[104:107], v7 offset:32768
    s_add_u32 m0, s42, 77824
    s_mov_b32 s41, 1490944
    buffer_load_dwordx4 v11, s[12:15], s41 offen lds
    s_waitcnt lgkmcnt(3)
    v_mfma_f32_32x32x16_bf16 v[160:175], a[124:127], v[44:47], v[160:175]
    ds_read_b128 a[108:111], v7 offset:36864
    s_add_u32 m0, s42, 81920
    s_mov_b32 s41, 1548288
    buffer_load_dwordx4 v11, s[12:15], s41 offen lds
    s_waitcnt lgkmcnt(3)
    v_mfma_f32_32x32x16_bf16 v[144:159], a[96:99], v[48:51], v[144:159]
    ds_read_b128 a[112:115], v6 offset:40960
    v_lshlrev_b32 v200, 16, v204
    v_and_b32 v201, 0xffff0000, v204
    v_lshlrev_b32 v202, 16, v205
    v_and_b32 v203, 0xffff0000, v205
    s_waitcnt lgkmcnt(3)
    v_mfma_f32_32x32x16_bf16 v[160:175], a[100:103], v[48:51], v[160:175]
    ds_read_b128 a[116:119], v7 offset:40960
    s_add_u32 m0, s42, 86016
    s_mov_b32 s41, 0
    buffer_load_dwordx4 v11, s[16:19], s41 offen lds
    s_waitcnt lgkmcnt(3)
    v_mfma_f32_32x32x16_bf16 v[144:159], a[104:107], v[52:55], v[144:159]
    s_waitcnt vmcnt(8)
    s_barrier
    ds_read_b128 a[120:123], v6 offset:49152
    s_add_u32 m0, s42, 90112
    s_mov_b32 s41, 57344
    buffer_load_dwordx4 v11, s[16:19], s41 offen lds
    s_waitcnt lgkmcnt(3)
    v_mfma_f32_32x32x16_bf16 v[160:175], a[108:111], v[52:55], v[160:175]
    ds_read_b128 a[124:127], v7 offset:49152
    v_lshlrev_b32 v204, 16, v206
    v_and_b32 v205, 0xffff0000, v206
    v_lshlrev_b32 v206, 16, v207
    v_and_b32 v207, 0xffff0000, v207
    s_waitcnt lgkmcnt(3)
    v_mfma_f32_32x32x16_bf16 v[144:159], a[112:115], v[56:59], v[144:159]
    ds_read_b128 a[96:99], v6 offset:45056
    s_add_u32 m0, s42, 94208
    s_mov_b32 s41, 114688
    buffer_load_dwordx4 v11, s[16:19], s41 offen lds
    s_waitcnt lgkmcnt(3)
    v_mfma_f32_32x32x16_bf16 v[144:159], a[116:119], v[60:63], v[144:159]
    ds_read_b128 a[100:103], v7 offset:45056
    s_waitcnt lgkmcnt(3)
    v_mfma_f32_32x32x16_bf16 v[144:159], a[120:123], v[64:67], v[144:159]
    ds_read_b128 a[104:107], v6 offset:53248
    s_add_u32 m0, s42, 98304
    s_mov_b32 s41, 974848
    buffer_load_dwordx4 v11, s[16:19], s41 offen lds
    s_waitcnt lgkmcnt(3)
    v_mfma_f32_32x32x16_bf16 v[144:159], a[124:127], v[68:71], v[144:159]
    ds_read_b128 a[108:111], v7 offset:53248
    s_add_u32 m0, s42, 102400
    s_mov_b32 s41, 1032192
    buffer_load_dwordx4 v11, s[16:19], s41 offen lds
    s_waitcnt lgkmcnt(3)
    v_mfma_f32_32x32x16_bf16 v[160:175], a[96:99], v[56:59], v[160:175]
    s_waitcnt lgkmcnt(2)
    v_mfma_f32_32x32x16_bf16 v[160:175], a[100:103], v[60:63], v[160:175]
    s_add_u32 m0, s42, 106496
    s_mov_b32 s41, 1089536
    buffer_load_dwordx4 v11, s[16:19], s41 offen lds
    s_waitcnt lgkmcnt(1)
    v_mfma_f32_32x32x16_bf16 v[160:175], a[104:107], v[64:67], v[160:175]
    v_cvt_pk_bf16_f32 v16, v144, v145
    v_cvt_pk_bf16_f32 v17, v146, v147
    v_cvt_pk_bf16_f32 v18, v148, v149
    v_cvt_pk_bf16_f32 v19, v150, v151
    ds_write_b128 v9, v[16:19]
    s_waitcnt lgkmcnt(1)
    v_mfma_f32_32x32x16_bf16 v[160:175], a[108:111], v[68:71], v[160:175]
    v_cvt_pk_bf16_f32 v20, v152, v153
    v_cvt_pk_bf16_f32 v21, v154, v155
    v_cvt_pk_bf16_f32 v22, v156, v157
    v_cvt_pk_bf16_f32 v23, v158, v159
    ds_write_b128 v9, v[20:23] offset:1024
    s_nop 6
    v_cvt_pk_bf16_f32 v24, v160, v161
    v_cvt_pk_bf16_f32 v25, v162, v163
    v_cvt_pk_bf16_f32 v26, v164, v165
    v_cvt_pk_bf16_f32 v27, v166, v167
    ds_write_b128 v9, v[24:27] offset:2048
    v_cvt_pk_bf16_f32 v28, v168, v169
    v_cvt_pk_bf16_f32 v29, v170, v171
    v_cvt_pk_bf16_f32 v30, v172, v173
    v_cvt_pk_bf16_f32 v31, v174, v175
    ds_write_b128 v9, v[28:31] offset:3072
    v_mfma_f32_32x32x16_bf16 v[208:223], v[136:139], a[236:239], 0
    v_accvgpr_write_b32 a239, v140
    v_mov_b32 v6, s3
    v_mov_b32 v7, s3
    v_mfma_f32_32x32x16_bf16 v[224:239], v[136:139], a[236:239], 0
    s_waitcnt lgkmcnt(0)
    s_barrier
    ds_read_b128 v[104:107], v2
    ds_read_b128 v[108:111], v2 offset:4096
    ds_read_b128 v[112:115], v2 offset:1024
    ds_read_b128 v[116:119], v2 offset:5120
    ds_read_b128 v[120:123], v2 offset:2048
    ds_read_b128 v[124:127], v2 offset:6144
    s_cmp_lg_u32 s33, 0
    s_cbranch_scc1 M_NODC2
    v_lshlrev_b32 v8, 4, v4
    v_cmp_eq_u32 vcc, 0, v3
    v_add_u32 v9, 160768, v8
    v_add_u32 v15, 161024, v8
    v_cndmask_b32 v9, v15, v9, vcc
    ds_read_b128 v[176:179], v9
    ds_read_b128 v[180:183], v9 offset:32
    ds_read_b128 v[184:187], v9 offset:64
    ds_read_b128 v[188:191], v9 offset:96
    ds_read_b128 v[240:243], v9 offset:128
    ds_read_b128 v[244:247], v9 offset:160
    ds_read_b128 v[248:251], v9 offset:192
    ds_read_b128 v[252:255], v9 offset:224
    s_waitcnt lgkmcnt(4)
    v_mfma_f32_32x32x16_bf16 v[176:191], v[104:107], v[72:75], v[176:191]
    s_waitcnt lgkmcnt(0)
    v_mfma_f32_32x32x16_bf16 v[240:255], v[108:111], v[72:75], v[240:255]
    s_branch M_DC2D
M_NODC2:
    s_waitcnt lgkmcnt(5)
    v_mfma_f32_32x32x16_bf16 v[176:191], v[104:107], v[72:75], 0
    s_waitcnt lgkmcnt(4)
    v_mfma_f32_32x32x16_bf16 v[240:255], v[108:111], v[72:75], 0
M_DC2D:
    ds_read_b128 v[128:131], v2 offset:3072
    s_add_u32 m0, s42, 0
    s_mov_b32 s41, 172032
    buffer_load_dwordx4 v11, s[16:19], s41 offen lds
    s_waitcnt lgkmcnt(4)
    v_mfma_f32_32x32x16_bf16 v[176:191], v[112:115], v[76:79], v[176:191]
    ds_read_b128 v[132:135], v2 offset:7168
    s_waitcnt lgkmcnt(4)
    v_mfma_f32_32x32x16_bf16 v[240:255], v[116:119], v[76:79], v[240:255]
    ds_read_b128 v[32:35], v2 offset:8192
    s_add_u32 m0, s42, 4096
    s_mov_b32 s41, 229376
    buffer_load_dwordx4 v11, s[16:19], s41 offen lds
    s_waitcnt lgkmcnt(4)
    v_mfma_f32_32x32x16_bf16 v[176:191], v[120:123], v[88:91], v[176:191]
    ds_read_b128 v[36:39], v2 offset:12288
    s_waitcnt lgkmcnt(4)
    v_mfma_f32_32x32x16_bf16 v[240:255], v[124:127], v[88:91], v[240:255]
    ds_read_b128 v[40:43], v2 offset:9216
    s_add_u32 m0, s42, 8192
    s_mov_b32 s41, 286720
    buffer_load_dwordx4 v11, s[16:19], s41 offen lds
    s_waitcnt lgkmcnt(4)
    v_mfma_f32_32x32x16_bf16 v[176:191], v[128:131], v[92:95], v[176:191]
    ds_read_b128 v[44:47], v2 offset:13312
    s_waitcnt lgkmcnt(4)
    v_mfma_f32_32x32x16_bf16 v[240:255], v[132:135], v[92:95], v[240:255]
    ds_read_b128 v[48:51], v2 offset:10240
    s_add_u32 m0, s42, 12288
    s_mov_b32 s41, 344064
    buffer_load_dwordx4 v11, s[16:19], s41 offen lds
    s_waitcnt lgkmcnt(4)
    v_mfma_f32_32x32x16_bf16 v[176:191], v[32:35], v[80:83], v[176:191]
    ds_read_b128 v[52:55], v2 offset:14336
    s_waitcnt lgkmcnt(4)
    v_mfma_f32_32x32x16_bf16 v[240:255], v[36:39], v[80:83], v[240:255]
    ds_read_b128 v[56:59], v2 offset:11264
    s_add_u32 m0, s42, 16384
    s_mov_b32 s41, 401408
    buffer_load_dwordx4 v11, s[16:19], s41 offen lds
    s_waitcnt lgkmcnt(4)
    v_mfma_f32_32x32x16_bf16 v[176:191], v[40:43], v[84:87], v[176:191]
    ds_read_b128 v[60:63], v2 offset:15360
    s_waitcnt lgkmcnt(4)
    v_mfma_f32_32x32x16_bf16 v[240:255], v[44:47], v[84:87], v[240:255]
    s_add_u32 m0, s42, 20480
    s_mov_b32 s41, 458752
    buffer_load_dwordx4 v11, s[16:19], s41 offen lds
    s_waitcnt lgkmcnt(3)
    v_mfma_f32_32x32x16_bf16 v[176:191], v[48:51], v[96:99], v[176:191]
    s_waitcnt lgkmcnt(2)
    v_mfma_f32_32x32x16_bf16 v[240:255], v[52:55], v[96:99], v[240:255]
    s_add_u32 m0, s42, 24576
    s_mov_b32 s41, 516096
    buffer_load_dwordx4 v11, s[16:19], s41 offen lds
    s_waitcnt lgkmcnt(1)
    v_mfma_f32_32x32x16_bf16 v[176:191], v[56:59], v[100:103], v[176:191]
    s_waitcnt lgkmcnt(0)
    v_mfma_f32_32x32x16_bf16 v[240:255], v[60:63], v[100:103], v[240:255]
    s_add_u32 m0, s42, 28672
    s_mov_b32 s41, 573440
    buffer_load_dwordx4 v11, s[16:19], s41 offen lds
    s_nop 8
    v_pk_fma_f32 v[176:177], v[240:241], v[6:7], v[176:177]
    v_pk_fma_f32 v[178:179], v[242:243], v[6:7], v[178:179]
    v_pk_fma_f32 v[180:181], v[244:245], v[6:7], v[180:181]
    v_pk_fma_f32 v[182:183], v[246:247], v[6:7], v[182:183]
    v_pk_fma_f32 v[192:193], v[208:209], v[176:177], v[192:193]
    v_pk_fma_f32 v[194:195], v[210:211], v[178:179], v[194:195]
    v_pk_fma_f32 v[196:197], v[212:213], v[180:181], v[196:197]
    v_pk_fma_f32 v[198:199], v[214:215], v[182:183], v[198:199]
    v_pk_mul_f32 v[144:145], v[192:193], v[224:225]
    v_pk_mul_f32 v[146:147], v[194:195], v[226:227]
    v_pk_mul_f32 v[148:149], v[196:197], v[228:229]
    v_pk_mul_f32 v[150:151], v[198:199], v[230:231]
    v_cvt_pk_bf16_f32 v16, v144, v145
    v_cvt_pk_bf16_f32 v17, v146, v147
    v_cvt_pk_bf16_f32 v18, v148, v149
    v_cvt_pk_bf16_f32 v19, v150, v151
    buffer_store_dwordx4 v[16:19], v2, s[8:11], s48 offen sc1
    v_pk_fma_f32 v[184:185], v[248:249], v[6:7], v[184:185]
    v_pk_fma_f32 v[186:187], v[250:251], v[6:7], v[186:187]
    v_pk_fma_f32 v[188:189], v[252:253], v[6:7], v[188:189]
    v_pk_fma_f32 v[190:191], v[254:255], v[6:7], v[190:191]
    v_pk_fma_f32 v[200:201], v[216:217], v[184:185], v[200:201]
    v_pk_fma_f32 v[202:203], v[218:219], v[186:187], v[202:203]
    v_pk_fma_f32 v[204:205], v[220:221], v[188:189], v[204:205]
    v_pk_fma_f32 v[206:207], v[222:223], v[190:191], v[206:207]
    v_pk_mul_f32 v[152:153], v[200:201], v[232:233]
    v_pk_mul_f32 v[154:155], v[202:203], v[234:235]
    v_pk_mul_f32 v[156:157], v[204:205], v[236:237]
    v_pk_mul_f32 v[158:159], v[206:207], v[238:239]
    v_cvt_pk_bf16_f32 v20, v152, v153
    v_cvt_pk_bf16_f32 v21, v154, v155
    v_cvt_pk_bf16_f32 v22, v156, v157
    v_cvt_pk_bf16_f32 v23, v158, v159
    buffer_store_dwordx4 v[20:23], v2, s[8:11], s48 offen offset:1024 sc1
    v_pk_add_f32 v[6:7], v[192:193], v[194:195]
    v_pk_mul_f32 v[8:9], v[192:193], v[192:193]
    v_pk_fma_f32 v[8:9], v[194:195], v[194:195], v[8:9]
    v_pk_add_f32 v[6:7], v[6:7], v[196:197]
    v_pk_fma_f32 v[8:9], v[196:197], v[196:197], v[8:9]
    v_pk_add_f32 v[6:7], v[6:7], v[198:199]
    v_pk_fma_f32 v[8:9], v[198:199], v[198:199], v[8:9]
    v_pk_add_f32 v[6:7], v[6:7], v[200:201]
    v_pk_fma_f32 v[8:9], v[200:201], v[200:201], v[8:9]
    v_pk_add_f32 v[6:7], v[6:7], v[202:203]
    v_pk_fma_f32 v[8:9], v[202:203], v[202:203], v[8:9]
    v_pk_add_f32 v[6:7], v[6:7], v[204:205]
    v_pk_fma_f32 v[8:9], v[204:205], v[204:205], v[8:9]
    v_pk_add_f32 v[6:7], v[6:7], v[206:207]
    v_pk_fma_f32 v[8:9], v[206:207], v[206:207], v[8:9]
    v_add_f32 v6, v6, v7
    v_add_f32 v7, v8, v9
    s_nop 1
    v_permlane32_swap_b32 v6, v7
    v_add_f32 v6, v6, v7
    buffer_store_dword v6, v5, s[8:11], s47 offen sc1
    v_add_u32 v7, 57, v1
    v_mul_u32_u24 v6, 128, v1
    v_lshrrev_b32 v7, 6, v7
    v_lshl_add_u32 v6, v7, 30, v6
    s_mul_i32 s58, s30, 896
    s_add_u32 s58, s58, 2555904
    buffer_load_dword v7, v6, s[8:11], s58 offen sc1
    s_add_u32 m0, s42, 32768
    s_mov_b32 s41, 630784
    buffer_load_dwordx4 v11, s[16:19], s41 offen lds
    s_add_u32 m0, s42, 36864
    s_mov_b32 s41, 688128
    buffer_load_dwordx4 v11, s[16:19], s41 offen lds
    s_add_u32 m0, s42, 40960
    s_mov_b32 s41, 745472
    buffer_load_dwordx4 v11, s[16:19], s41 offen lds
    s_add_u32 m0, s42, 45056
    s_mov_b32 s41, 802816
    buffer_load_dwordx4 v11, s[16:19], s41 offen lds
    s_add_u32 m0, s42, 49152
    s_mov_b32 s41, 860160
    buffer_load_dwordx4 v11, s[16:19], s41 offen lds
    s_add_u32 m0, s42, 53248
    s_mov_b32 s41, 917504
    buffer_load_dwordx4 v11, s[16:19], s41 offen lds
    s_cmp_ge_u32 s32, 7
    s_cselect_b32 s55, 1, 0
    s_lshl_b32 s47, s31, 2
    s_add_u32 s47, s47, s55
    s_mul_i32 s50, s47, 114688
    s_mul_i32 s47, s47, 28672
    s_mul_i32 s48, s30, 7168
    s_add_u32 s47, s47, s48
    s_add_u32 s47, s47, 2883584
    s_lshl_b32 s49, s31, 2
    s_xor_b32 s3, s30, s55
    s_add_u32 s49, s49, s3
    s_mul_i32 s49, s49, 3584
    s_add_u32 s49, s49, 2293760
    s_mul_i32 s3, s30, 28672
    s_add_u32 s50, s50, s3
    s_lshl_b32 s40, s32, 11
    s_add_u32 s50, s50, s40
    s_add_u32 s50, s50, 6356992
    s_mul_i32 s53, s46, 114688
    s_add_u32 s53, s53, s3
    s_add_u32 s53, s53, 6356992
    s_and_b32 s3, s28, 1
    s_mul_i32 s3, s3, 14336
    s_sub_u32 s35, s53, s3
    s_add_u32 s35, s35, 14336
    s_add_u32 s53, s53, s3
    s_lshl_b32 s51, s29, 2
    s_add_u32 s51, s51, s30
    s_mul_i32 s51, s51, 57344
    s_add_u32 s51, s51, 4718592
    s_lshl_b32 s3, s3, 1
    s_sub_u32 s52, s51, s3
    s_add_u32 s52, s52, 28672
    s_add_u32 s51, s51, s3
    s_mul_i32 s3, s55, 57344
    s_sub_u32 s56, 24576, s3
    s_add_u32 s36, s3, 24576
    s_mul_i32 s3, s55, 229376
    s_sub_u32 s57, 114688, s3
    s_add_u32 s37, s3, 114688
    s_waitcnt vmcnt(7)
    v_mov_b32 v15, 1
    buffer_store_dword v15, v13, s[8:11], s38 offen sc1
    s_add_u32 m0, s42, 110592
    s_mov_b32 s41, 1146880
    buffer_load_dwordx4 v11, s[16:19], s41 offen lds
    s_add_u32 m0, s42, 114688
    s_mov_b32 s41, 1204224
    buffer_load_dwordx4 v11, s[16:19], s41 offen lds
    s_add_u32 m0, s42, 118784
    s_mov_b32 s41, 1261568
    buffer_load_dwordx4 v11, s[16:19], s41 offen lds
    s_add_u32 m0, s42, 122880
    s_mov_b32 s41, 1318912
    buffer_load_dwordx4 v11, s[16:19], s41 offen lds
    s_add_u32 m0, s42, 126976
    s_mov_b32 s41, 1376256
    buffer_load_dwordx4 v11, s[16:19], s41 offen lds
    s_add_u32 m0, s42, 131072
    s_mov_b32 s41, 1433600
    buffer_load_dwordx4 v11, s[16:19], s41 offen lds
    s_add_u32 m0, s42, 135168
    s_mov_b32 s41, 1490944
    buffer_load_dwordx4 v11, s[16:19], s41 offen lds
    s_add_u32 m0, s42, 139264
    s_mov_b32 s41, 1548288
    buffer_load_dwordx4 v11, s[16:19], s41 offen lds
    s_waitcnt vmcnt(15)
    v_cmp_gt_u32 vcc, 1, v7
    s_nop 0
    s_and_b32 vcc_lo, vcc_lo, 127
    s_cbranch_scc1 CHK5S
CHK5:
    v_add_u32 v9, 50, v1
    v_mul_u32_u24 v8, 32, v1
    v_lshrrev_b32 v9, 6, v9
    v_lshl_add_u32 v8, v9, 30, v8
    s_lshl_b32 s59, s31, 6
    s_mul_i32 s3, s30, 14
    s_add_u32 s59, s59, s3
    s_mul_i32 s59, s59, 32
    s_add_u32 s59, s59, 2588672
    s_lshl_b32 s4, s32, 11
    s_lshl_b32 s40, s30, 9
    s_add_u32 s4, s4, s40
    s_add_u32 s4, s4, 1835008
    s_lshr_b32 s12, s28, 1
    s_lshl_b32 s12, s12, 6
    s_lshl_b32 s3, s30, 4
    s_add_u32 s12, s12, s3
    s_mul_i32 s12, s12, 128
    s_add_u32 s12, s12, 2719744
    s_lshl_b32 s3, s32, 1
    s_cmp_ge_u32 s32, 7
    s_cselect_b32 s40, 13, 0
    s_sub_u32 s3, s3, s40
    s_cmp_ge_u32 s31, 8
    s_cselect_b32 s40, 14, 0
    s_cselect_b32 s13, 30, 28
    s_add_u32 s3, s3, s40
    s_and_b32 s40, s3, 1
    s_add_u32 s13, s13, s40
    s_and_b32 s40, s31, 7
    s_cmp_eq_u32 s40, 7
    s_cselect_b32 s3, s13, s3
    s_lshl_b32 s3, s3, 2
    s_add_u32 s3, s3, s30
    s_lshl_b32 s3, s3, 6
    s_add_u32 s13, s3, 2560000
    s_mul_i32 s43, s30, 11264
    s_add_u32 s43, s43, 114688
    s_mul_i32 s44, s30, 7168
    s_lshr_b32 s40, s30, 1
    s_waitcnt vmcnt(9)
    s_barrier
    buffer_load_dwordx4 a[224:227], v2, s[8:11], s51 offen sc1
    buffer_load_dwordx4 a[228:231], v2, s[8:11], s51 offen offset:1024 sc1
    ds_read_b64_tr_b16 a[84:85], v12 offset:57344
    s_lshl_b32 s40, s40, 4
    ds_read_b64_tr_b16 a[86:87], v12 offset:59392
    s_add_u32 s40, s40, s34
    ds_read_b64_tr_b16 a[88:89], v12 offset:61440
    s_lshl_b32 s5, s40, 2
    ds_read_b64_tr_b16 a[90:91], v12 offset:63488
    s_add_u32 s5, s5, 2548480
    ds_read_b64_tr_b16 a[92:93], v14
    s_lshl_b32 s40, s40, 1
    ds_read_b64_tr_b16 a[94:95], v14 offset:2048
    s_mul_i32 s6, s28, 896
    ds_read_b64_tr_b16 a[96:97], v14 offset:4096
    s_add_u32 s6, s6, s40
    ds_read_b64_tr_b16 a[98:99], v14 offset:6144
    s_mul_i32 s7, s54, 896
    ds_read_b64_tr_b16 a[100:101], v14 offset:8192
    s_add_u32 s7, s7, s40
    ds_read_b64_tr_b16 a[102:103], v14 offset:10240
    s_lshl_b32 s15, s30, 13
    ds_read_b64_tr_b16 a[104:105], v14 offset:12288
    s_add_u32 s15, s15, 65536
    ds_read_b64_tr_b16 a[106:107], v14 offset:14336
    s_and_b32 s3, s30, 1
    ds_read_b64_tr_b16 a[108:109], v14 offset:16384
    s_lshr_b32 s40, s30, 1
    ds_read_b64_tr_b16 a[110:111], v14 offset:18432
    s_lshl_b32 s3, s3, 1
    ds_read_b64_tr_b16 a[112:113], v14 offset:20480
    s_add_u32 s3, s3, s40
    ds_read_b64_tr_b16 a[114:115], v14 offset:22528
    s_lshl_b32 s46, s3, 11
    ds_read_b64_tr_b16 a[116:117], v14 offset:24576
    s_lshl_b32 s54, s30, 12
    ds_read_b64_tr_b16 a[118:119], v14 offset:26624
    s_lshl_b32 s34, s30, 8
    ds_read_b64_tr_b16 a[120:121], v14 offset:28672
    s_add_u32 s34, s34, 159744
    ds_read_b64_tr_b16 a[122:123], v14 offset:30720
    v_add_u32 v255, 32768, v14
    ds_read_b64_tr_b16 a[124:125], v12
    v_lshl_add_u32 v5, v4, 30, v2
    ds_read_b64_tr_b16 a[126:127], v12 offset:2048
    s_lshl_b32 s28, s30, 10
    ds_read_b64_tr_b16 a[128:129], v12 offset:4096
    s_sub_u32 s31, s47, s48
    ds_read_b64_tr_b16 a[130:131], v12 offset:6144
    s_add_u32 s31, s31, s28
    ds_read_b64_tr_b16 a[132:133], v12 offset:8192
    s_lshl_b32 s24, s29, 11
    ds_read_b64_tr_b16 a[134:135], v12 offset:10240
    s_add_u32 s25, s24, 2048
    ds_read_b64_tr_b16 a[136:137], v12 offset:12288
    s_cmp_eq_u32 s25, 14336
    ds_read_b64_tr_b16 a[138:139], v12 offset:14336
    s_cselect_b32 s25, 0, s25
    ds_read_b64_tr_b16 a[140:141], v12 offset:16384
    s_add_u32 s26, s25, 2048
    ds_read_b64_tr_b16 a[142:143], v12 offset:18432
    s_cmp_eq_u32 s26, 14336
    ds_read_b64_tr_b16 a[144:145], v12 offset:20480
    s_cselect_b32 s26, 0, s26
    ds_read_b64_tr_b16 a[146:147], v12 offset:22528
    s_add_u32 s27, s26, 2048
    ds_read_b64_tr_b16 a[148:149], v12 offset:24576
    s_cmp_eq_u32 s27, 14336
    ds_read_b64_tr_b16 a[150:151], v12 offset:26624
    s_cselect_b32 s27, 0, s27
    ds_read_b64_tr_b16 a[152:153], v12 offset:28672
    s_add_u32 s33, s27, 2048
    ds_read_b64_tr_b16 a[154:155], v12 offset:30720
    s_cmp_eq_u32 s33, 14336
    ds_read_b64_tr_b16 a[156:157], v12 offset:32768
    s_cselect_b32 s33, 0, s33
    ds_read_b64_tr_b16 a[158:159], v12 offset:34816
    s_add_u32 s38, s33, 2048
    ds_read_b64_tr_b16 a[160:161], v12 offset:36864
    s_cmp_eq_u32 s38, 14336
    ds_read_b64_tr_b16 a[162:163], v12 offset:38912
    s_cselect_b32 s38, 0, s38
    ds_read_b64_tr_b16 a[164:165], v12 offset:40960
    s_add_u32 s32, s38, 2048
    ds_read_b64_tr_b16 a[166:167], v12 offset:43008
    s_cmp_eq_u32 s32, 14336
    ds_read_b64_tr_b16 a[168:169], v12 offset:45056
    s_cselect_b32 s32, 0, s32
    ds_read_b64_tr_b16 a[170:171], v12 offset:47104
    ds_read_b64_tr_b16 a[172:173], v12 offset:49152
    ds_read_b64_tr_b16 a[174:175], v12 offset:51200
    ds_read_b64_tr_b16 a[176:177], v12 offset:53248
    ds_read_b64_tr_b16 a[178:179], v12 offset:55296
    buffer_load_dword v15, v8, s[8:11], s59 offen sc1
    s_waitcnt vmcnt(0)
    v_cmp_gt_u32 vcc, 1, v15
    s_nop 0
    s_and_b32 vcc_lo, vcc_lo, 16383
    s_cbranch_scc0 CHK6
    s_mov_b32 s55, 0
POLL7:
    buffer_load_dword v15, v8, s[8:11], s59 offen sc1
    s_add_u32 s55, s55, 1
    s_waitcnt vmcnt(0)
    v_cmp_gt_u32 vcc, 1, v15
    s_nop 0
    s_and_b32 vcc_lo, vcc_lo, 16383
    s_cbranch_scc0 POLL7D
    s_cmp_lt_u32 s55, 20000
    s_cbranch_scc1 POLL7
POLL7D:
CHK6:
    s_waitcnt lgkmcnt(0)
    s_barrier
    s_add_u32 m0, s28, 0
    s_add_u32 s3, s31, 0
    buffer_load_dwordx4 v2, s[8:11], s3 offen sc1 lds
    s_add_u32 m0, s28, 4096
    s_add_u32 s3, s31, 4096
    buffer_load_dwordx4 v2, s[8:11], s3 offen sc1 lds
    s_add_u32 m0, s28, 8192
    s_add_u32 s3, s31, 8192
    buffer_load_dwordx4 v2, s[8:11], s3 offen sc1 lds
    s_add_u32 m0, s28, 12288
    s_add_u32 s3, s31, 12288
    buffer_load_dwordx4 v2, s[8:11], s3 offen sc1 lds
    s_add_u32 m0, s28, 16384
    s_add_u32 s3, s31, 16384
    buffer_load_dwordx4 v2, s[8:11], s3 offen sc1 lds
    s_add_u32 m0, s28, 20480
    s_add_u32 s3, s31, 20480
    buffer_load_dwordx4 v2, s[8:11], s3 offen sc1 lds
    s_add_u32 m0, s28, 24576
    s_add_u32 s3, s31, 24576
    buffer_load_dwordx4 v2, s[8:11], s3 offen sc1 lds
    s_add_u32 s48, s48, 28672
    s_add_u32 s47, s47, 4096
    s_add_u32 s47, s47, s56
    s_mov_b32 m0, s48
    s_add_u32 s48, s48, 4096
    buffer_load_dwordx4 v2, s[8:11], s47 offen sc1 lds
    buffer_load_dwordx4 v2, s[8:11], s47 offen offset:1024 sc1 lds
    buffer_load_dwordx4 v2, s[8:11], s47 offen offset:2048 sc1 lds
    buffer_load_dwordx4 v2, s[8:11], s47 offen offset:3072 sc1 lds
    s_add_u32 s47, s47, 4096
    s_mov_b32 m0, s48
    s_add_u32 s48, s48, 24576
    buffer_load_dwordx4 v2, s[8:11], s47 offen sc1 lds
    s_waitcnt vmcnt(9)
    s_barrier
    ds_read_b128 v[80:83], v2
    ds_read_b128 v[84:87], v2 offset:1024
    ds_read_b128 v[88:91], v2 offset:2048
    ds_read_b128 v[92:95], v2 offset:3072
    ds_read_b128 v[96:99], v2 offset:4096
    s_waitcnt lgkmcnt(4)
    v_mfma_f32_32x32x16_bf16 v[16:31], a[0:3], v[80:83], 0
    buffer_load_dwordx4 v[112:115], v2, s[8:11], s49 offen sc1
    v_mfma_f32_32x32x16_bf16 v[32:47], a[112:115], v[80:83], 0
    ds_read_b128 v[100:103], v2 offset:5120
    s_waitcnt lgkmcnt(4)
    v_mfma_f32_32x32x16_bf16 v[16:31], a[4:7], v[84:87], v[16:31]
    buffer_load_dwordx4 v[116:119], v2, s[8:11], s49 offen offset:1024 sc1
    v_mfma_f32_32x32x16_bf16 v[32:47], a[116:119], v[84:87], v[32:47]
    ds_read_b128 v[104:107], v2 offset:6144
    s_waitcnt lgkmcnt(4)
    v_mfma_f32_32x32x16_bf16 v[16:31], a[8:11], v[88:91], v[16:31]
    v_mfma_f32_32x32x16_bf16 v[32:47], a[120:123], v[88:91], v[32:47]
    ds_read_b128 v[108:111], v2 offset:7168
    buffer_load_dwordx4 v[120:123], v2, s[8:11], s49 offen offset:2048 sc1
    s_waitcnt lgkmcnt(4)
    v_mfma_f32_32x32x16_bf16 v[16:31], a[12:15], v[92:95], v[16:31]
    v_mfma_f32_32x32x16_bf16 v[32:47], a[124:127], v[92:95], v[32:47]
    ds_read_b128 v[80:83], v2 offset:8192
    buffer_load_dwordx4 v[124:127], v5, s[8:11], s49 offen offset:3072 sc1
    s_waitcnt lgkmcnt(4)
    v_mfma_f32_32x32x16_bf16 v[16:31], a[16:19], v[96:99], v[16:31]
    v_mfma_f32_32x32x16_bf16 v[32:47], a[128:131], v[96:99], v[32:47]
    ds_read_b128 v[84:87], v2 offset:9216
    s_waitcnt lgkmcnt(4)
    v_mfma_f32_32x32x16_bf16 v[16:31], a[20:23], v[100:103], v[16:31]
    buffer_load_dwordx4 v2, s[8:11], s47 offen offset:1024 sc1 lds
    v_mfma_f32_32x32x16_bf16 v[32:47], a[132:135], v[100:103], v[32:47]
    ds_read_b128 v[88:91], v2 offset:10240
    s_waitcnt lgkmcnt(4)
    v_mfma_f32_32x32x16_bf16 v[16:31], a[24:27], v[104:107], v[16:31]
    buffer_load_dwordx4 v2, s[8:11], s47 offen offset:2048 sc1 lds
    s_add_u32 s47, s47, s36
    v_mfma_f32_32x32x16_bf16 v[32:47], a[136:139], v[104:107], v[32:47]
    ds_read_b128 v[92:95], v2 offset:11264
    s_waitcnt lgkmcnt(4)
    v_mfma_f32_32x32x16_bf16 v[16:31], a[28:31], v[108:111], v[16:31]
    s_waitcnt vmcnt(11)
    s_barrier
    v_add_u32 v11, 57344, v2
    v_mfma_f32_32x32x16_bf16 v[32:47], a[140:143], v[108:111], v[32:47]
    ds_read_b128 v[96:99], v2 offset:12288
    ds_read_b64_tr_b16 a[180:181], v255
    ds_read_b64_tr_b16 a[182:183], v255 offset:2048
    s_mov_b32 m0, s48
    s_add_u32 s48, s48, 4096
    buffer_load_dwordx4 v2, s[8:11], s47 offen sc1 lds
    s_waitcnt lgkmcnt(6)
    v_mfma_f32_32x32x16_bf16 v[16:31], a[32:35], v[80:83], v[16:31]
    v_mov_b32 v188, 0
    v_mov_b32 v189, 0
    v_mov_b32 v190, 0
    v_mov_b32 v191, 0
    v_mul_u32_u24 v10, 28160, v4
    v_add_u32 v10, v10, v2
    ds_read_b64_tr_b16 a[184:185], v255 offset:4096
    v_mfma_f32_32x32x16_bf16 v[32:47], a[144:147], v[80:83], v[32:47]
    ds_read_b128 v[100:103], v2 offset:13312
    buffer_load_dwordx4 v[184:187], v10, s[8:11], s4 offen sc1
    ds_read_b64_tr_b16 a[186:187], v255 offset:6144
    buffer_load_dwordx4 v2, s[8:11], s47 offen offset:1024 sc1 lds
    s_waitcnt lgkmcnt(8)
    v_mfma_f32_32x32x16_bf16 v[16:31], a[36:39], v[84:87], v[16:31]
    ds_read_b64_tr_b16 a[188:189], v255 offset:8192
    v_mfma_f32_32x32x16_bf16 v[32:47], a[148:151], v[84:87], v[32:47]
    ds_read_b128 v[104:107], v2 offset:14336
    ds_read_b64_tr_b16 a[190:191], v255 offset:10240
    ds_read_b64_tr_b16 a[192:193], v255 offset:12288
    s_waitcnt lgkmcnt(11)
    v_mfma_f32_32x32x16_bf16 v[16:31], a[40:43], v[88:91], v[16:31]
    ds_read_b64_tr_b16 a[194:195], v255 offset:14336
    buffer_load_dwordx4 v2, s[8:11], s47 offen offset:2048 sc1 lds
    v_mfma_f32_32x32x16_bf16 v[32:47], a[152:155], v[88:91], v[32:47]
    ds_read_b128 v[108:111], v2 offset:15360
    ds_read_b64_tr_b16 a[196:197], v255 offset:16384
    s_waitcnt lgkmcnt(13)
    v_mfma_f32_32x32x16_bf16 v[16:31], a[44:47], v[92:95], v[16:31]
    ds_read_b64_tr_b16 a[198:199], v255 offset:18432
    buffer_load_dwordx4 v2, s[8:11], s47 offen offset:3072 sc1 lds
    s_add_u32 s47, s47, 4096
    v_mfma_f32_32x32x16_bf16 v[32:47], a[156:159], v[92:95], v[32:47]
    ds_read_b128 v[80:83], v2 offset:16384
    ds_read_b64_tr_b16 a[200:201], v255 offset:20480
    ds_read_b64_tr_b16 a[202:203], v255 offset:22528
    s_waitcnt lgkmcnt(14)
    v_mfma_f32_32x32x16_bf16 v[16:31], a[48:51], v[96:99], v[16:31]
    ds_read_b64_tr_b16 a[204:205], v255 offset:24576
    v_mfma_f32_32x32x16_bf16 v[32:47], a[160:163], v[96:99], v[32:47]
    ds_read_b128 v[84:87], v2 offset:17408
    ds_read_b64_tr_b16 a[206:207], v255 offset:26624
    s_mov_b32 m0, s48
    s_add_u32 s48, s48, 24576
    buffer_load_dwordx4 v2, s[8:11], s47 offen sc1 lds
    s_waitcnt lgkmcnt(14)
    v_mfma_f32_32x32x16_bf16 v[16:31], a[52:55], v[100:103], v[16:31]
    ds_read_b64_tr_b16 a[208:209], v255 offset:28672
    v_mfma_f32_32x32x16_bf16 v[32:47], a[164:167], v[100:103], v[32:47]
    ds_read_b128 v[88:91], v2 offset:18432
    ds_read_b64_tr_b16 a[210:211], v255 offset:30720
    ds_read_b64_tr_b16 a[212:213], v255 offset:32768
    buffer_load_dwordx4 v2, s[8:11], s47 offen offset:1024 sc1 lds
    s_waitcnt lgkmcnt(14)
    v_mfma_f32_32x32x16_bf16 v[16:31], a[56:59], v[104:107], v[16:31]
    ds_read_b64_tr_b16 a[214:215], v255 offset:34816
    v_mfma_f32_32x32x16_bf16 v[32:47], a[168:171], v[104:107], v[32:47]
    ds_read_b128 v[92:95], v2 offset:19456
    ds_read_b64_tr_b16 a[216:217], v255 offset:36864
    s_waitcnt lgkmcnt(14)
    v_mfma_f32_32x32x16_bf16 v[16:31], a[60:63], v[108:111], v[16:31]
    ds_read_b64_tr_b16 a[218:219], v255 offset:38912
    buffer_load_dwordx4 v2, s[8:11], s47 offen offset:2048 sc1 lds
    s_add_u32 s47, s47, s56
    v_add_u32 v15, 50, v1
    v_mul_u32_u24 v6, 128, v1
    v_mfma_f32_32x32x16_bf16 v[32:47], a[172:175], v[108:111], v[32:47]
    ds_read_b128 v[96:99], v2 offset:20480
    ds_read_b64_tr_b16 a[220:221], v255 offset:40960
    ds_read_b64_tr_b16 a[222:223], v255 offset:43008
    v_lshrrev_b32 v15, 6, v15
    v_lshl_add_u32 v6, v15, 30, v6
    s_waitcnt lgkmcnt(14)
    v_mfma_f32_32x32x16_bf16 v[16:31], a[64:67], v[80:83], v[16:31]
    buffer_load_dwordx4 a[232:235], v2, s[8:11], s51 offen offset:2048 sc1
    v_add_u32 v15, 57, v1
    v_mul_u32_u24 v5, 2048, v1
    v_lshrrev_b32 v15, 6, v15
    v_lshl_add_u32 v5, v15, 30, v5
    v_mfma_f32_32x32x16_bf16 v[32:47], a[176:179], v[80:83], v[32:47]
    ds_read_b128 v[100:103], v2 offset:21504
    s_waitcnt vmcnt(11)
    v_add_f32 v120, v120, v124
    v_add_f32 v121, v121, v125
    v_add_f32 v122, v122, v126
    v_add_f32 v123, v123, v127
    s_waitcnt lgkmcnt(13)
    v_mfma_f32_32x32x16_bf16 v[16:31], a[68:71], v[84:87], v[16:31]
    v_add_f32 v112, v112, v116
    v_add_f32 v113, v113, v117
    v_add_f32 v114, v114, v118
    v_add_f32 v115, v115, v119
    v_add_f32 v112, v112, v120
    v_add_f32 v113, v113, v121
    v_mfma_f32_32x32x16_bf16 v[32:47], a[180:183], v[84:87], v[32:47]
    ds_read_b128 v[104:107], v2 offset:22528
    buffer_load_dwordx4 a[236:239], v2, s[8:11], s51 offen offset:3072 sc1
    s_add_u32 s51, s51, 4096
    v_add_f32 v114, v114, v122
    s_waitcnt lgkmcnt(11)
    v_mfma_f32_32x32x16_bf16 v[16:31], a[72:75], v[88:91], v[16:31]
    v_add_f32 v115, v115, v123
    v_bfe_u32 v8, v1, 4, 1
    v_and_b32 v14, 15, v1
    v_permlane32_swap_b32 v112, v114
    v_permlane32_swap_b32 v113, v115
    v_add_f32 v112, v112, v114
    v_mfma_f32_32x32x16_bf16 v[32:47], a[184:187], v[88:91], v[32:47]
    ds_read_b128 v[108:111], v2 offset:23552
    buffer_load_dwordx4 a[240:243], v2, s[8:11], s51 offen sc1
    v_add_f32 v113, v113, v115
    v_lshl_add_u32 v8, v4, 1, v8
    s_waitcnt lgkmcnt(8)
    v_mfma_f32_32x32x16_bf16 v[16:31], a[76:79], v[92:95], v[16:31]
    v_lshl_add_u32 v8, v14, 2, v8
    v_permlane16_swap_b32 v112, v113
    v_add_f32 v112, v112, v113
    v_lshl_add_u32 v8, v8, 2, s34
    v_mul_f32 v112, 0x3b124925, v112
    v_lshlrev_b32 v14, 2, v3
    v_mfma_f32_32x32x16_bf16 v[32:47], a[188:191], v[92:95], v[32:47]
    ds_read_b128 v[80:83], v2 offset:24576
    ds_write_b32 v8, v112
    v_add_u32 v8, 159744, v14
    s_waitcnt lgkmcnt(7)
    v_mfma_f32_32x32x16_bf16 v[16:31], a[80:83], v[96:99], v[16:31]
    buffer_load_dwordx4 a[244:247], v2, s[8:11], s51 offen offset:1024 sc1
    v_mfma_f32_32x32x16_bf16 v[32:47], a[192:195], v[96:99], v[32:47]
    ds_read_b128 v[84:87], v2 offset:25600
    s_waitcnt lgkmcnt(5)
    v_mfma_f32_32x32x16_bf16 v[16:31], a[84:87], v[100:103], v[16:31]
    s_mov_b32 m0, s48
    s_add_u32 s48, s48, 4096
    buffer_load_dwordx4 v2, s[8:11], s47 offen sc1 lds
    v_mfma_f32_32x32x16_bf16 v[32:47], a[196:199], v[100:103], v[32:47]
    ds_read_b128 v[88:91], v2 offset:26624
    s_waitcnt lgkmcnt(5)
    v_mfma_f32_32x32x16_bf16 v[16:31], a[88:91], v[104:107], v[16:31]
    s_waitcnt vmcnt(13)
    s_waitcnt lgkmcnt(2)
    s_barrier
    v_mfma_f32_32x32x16_bf16 v[32:47], a[200:203], v[104:107], v[32:47]
    ds_read_b128 v[92:95], v2 offset:27648
    buffer_load_dwordx4 v2, s[8:11], s47 offen offset:1024 sc1 lds
    ds_read2_b32 v[112:113], v8 offset0:0 offset1:32
    ds_read2_b32 v[114:115], v8 offset0:64 offset1:96
    v_mfma_f32_32x32x16_bf16 v[16:31], a[92:95], v[108:111], v[16:31]
    ds_read2_b32 v[116:117], v8 offset0:128 offset1:160
    ds_read2_b32 v[118:119], v8 offset0:192 offset1:224
    v_mfma_f32_32x32x16_bf16 v[32:47], a[204:207], v[108:111], v[32:47]
    ds_read_b128 v[96:99], v2 offset:28672
    s_waitcnt vmcnt(12)
    v_max3_u32 v12, v184, v185, v186
    v_max_u32 v12, v12, v187
    v_cmp_eq_u32 vcc, -1, v12
    s_nop 0
    s_cbranch_vccnz SLOWE
BACKE:
    buffer_load_dwordx4 v2, s[8:11], s47 offen offset:2048 sc1 lds
    v_mfma_f32_32x32x16_bf16 v[16:31], a[96:99], v[80:83], v[16:31]
    v_permlane32_swap_b32 v184, v188
    v_permlane32_swap_b32 v185, v189
    v_permlane32_swap_b32 v186, v190
    v_permlane32_swap_b32 v187, v191
    v_mfma_f32_32x32x16_bf16 v[32:47], a[208:211], v[80:83], v[32:47]
    ds_read_b128 v[100:103], v2 offset:29696
    s_waitcnt lgkmcnt(8)
    v_mfma_f32_32x32x16_bf16 v[16:31], a[100:103], v[84:87], v[16:31]
    buffer_load_dwordx4 v2, s[8:11], s47 offen offset:3072 sc1 lds
    s_add_u32 s47, s47, 4096
    s_waitcnt lgkmcnt(5)
    v_fma_f32 v113, -v112, v112, v113
    v_max_f32 v113, 0, v113
    v_add_f32 v113, 0x3727c5ac, v113
    v_mfma_f32_32x32x16_bf16 v[32:47], a[212:215], v[84:87], v[32:47]
    ds_read_b128 v[104:107], v2 offset:30720
    v_sqrt_f32 v152, v113
    v_rsq_f32 v156, v113
    v_mfma_f32_32x32x16_bf16 v[16:31], a[104:107], v[88:91], v[16:31]
    s_mov_b32 m0, s48
    s_add_u32 s48, s48, 24576
    buffer_load_dwordx4 v2, s[8:11], s47 offen sc1 lds
    v_cvt_pk_bf16_f32 v9, -v112, v152
    v_mul_f32 v156, 0xbfb8aa3b, v156
    v_mfma_f32_32x32x16_bf16 v[32:47], a[216:219], v[88:91], v[32:47]
    ds_read_b128 v[108:111], v2 offset:31744
    v_lshlrev_b32 v120, 16, v9
    v_and_b32 v121, 0xffff0000, v9
    v_sub_f32 v122, -v112, v120
    v_sub_f32 v123, v152, v121
    v_mfma_f32_32x32x16_bf16 v[16:31], a[108:111], v[92:95], v[16:31]
    v_cvt_pk_bf16_f32 v136, v120, v120
    v_cvt_pk_bf16_f32 v137, v122, v121
    v_cvt_pk_bf16_f32 v138, v121, v123
    v_mov_b32 v139, 0
    s_waitcnt lgkmcnt(6)
    v_fma_f32 v115, -v114, v114, v115
    v_max_f32 v115, 0, v115
    v_mfma_f32_32x32x16_bf16 v[32:47], a[220:223], v[92:95], v[32:47]
    ds_read_b128 v[80:83], v2 offset:32768
    buffer_load_dwordx4 v2, s[8:11], s47 offen offset:1024 sc1 lds
    v_add_f32 v115, 0x3727c5ac, v115
    v_mfma_f32_32x32x16_bf16 v[16:31], v[184:187], v[136:139], v[16:31]
    v_sqrt_f32 v153, v115
    v_rsq_f32 v157, v115
    v_cvt_pk_bf16_f32 v9, -v114, v153
    v_mul_f32 v157, 0xbfb8aa3b, v157
    v_mfma_f32_32x32x16_bf16 v[32:47], v[188:191], v[136:139], v[32:47]
    buffer_load_dwordx4 v2, s[8:11], s47 offen offset:2048 sc1 lds
    v_lshlrev_b32 v120, 16, v9
    v_and_b32 v121, 0xffff0000, v9
    v_sub_f32 v122, -v114, v120
    v_sub_f32 v123, v153, v121
    s_waitcnt lgkmcnt(4)
    v_mfma_f32_32x32x16_bf16 v[48:63], a[0:3], v[96:99], 0
    v_cvt_pk_bf16_f32 v140, v120, v120
    v_cvt_pk_bf16_f32 v141, v122, v121
    v_cvt_pk_bf16_f32 v142, v121, v123
    v_mov_b32 v143, 0
    v_fma_f32 v117, -v116, v116, v117
    v_max_f32 v117, 0, v117
    v_mfma_f32_32x32x16_bf16 v[64:79], a[112:115], v[96:99], 0
    ds_read_b128 v[84:87], v2 offset:33792
    v_add_f32 v117, 0x3727c5ac, v117
    v_sqrt_f32 v154, v117
    s_waitcnt lgkmcnt(4)
    v_mfma_f32_32x32x16_bf16 v[48:63], a[4:7], v[100:103], v[48:63]
    buffer_load_dwordx4 a[248:251], v2, s[8:11], s51 offen offset:2048 sc1
    v_rsq_f32 v158, v117
    v_cvt_pk_bf16_f32 v9, -v116, v154
    v_mul_f32 v158, 0xbfb8aa3b, v158
    v_mfma_f32_32x32x16_bf16 v[64:79], a[116:119], v[100:103], v[64:79]
    ds_read_b128 v[88:91], v2 offset:34816
    v_lshlrev_b32 v120, 16, v9
    v_and_b32 v121, 0xffff0000, v9
    v_sub_f32 v122, -v116, v120
    v_sub_f32 v123, v154, v121
    s_waitcnt lgkmcnt(4)
    v_mfma_f32_32x32x16_bf16 v[48:63], a[8:11], v[104:107], v[48:63]
    buffer_load_dwordx4 a[252:255], v2, s[8:11], s51 offen offset:3072 sc1
    s_add_u32 s51, s51, 4096
    v_cvt_pk_bf16_f32 v144, v120, v120
    v_cvt_pk_bf16_f32 v145, v122, v121
    v_cvt_pk_bf16_f32 v146, v121, v123
    v_mfma_f32_32x32x16_bf16 v[64:79], a[120:123], v[104:107], v[64:79]
    ds_read_b128 v[92:95], v2 offset:35840
    v_mov_b32 v147, 0
    v_fma_f32 v119, -v118, v118, v119
    v_max_f32 v119, 0, v119
    v_add_f32 v119, 0x3727c5ac, v119
    s_waitcnt lgkmcnt(4)
    v_mfma_f32_32x32x16_bf16 v[48:63], a[12:15], v[108:111], v[48:63]
    v_sqrt_f32 v155, v119
    v_rsq_f32 v159, v119
    v_cvt_pk_bf16_f32 v9, -v118, v155
    v_mul_f32 v159, 0xbfb8aa3b, v159
    v_mfma_f32_32x32x16_bf16 v[64:79], a[124:127], v[108:111], v[64:79]
    ds_read_b128 v[96:99], v2 offset:36864
    buffer_load_dwordx4 v[208:211], v2, s[8:11], s51 offen sc1
    v_lshlrev_b32 v120, 16, v9
    v_and_b32 v121, 0xffff0000, v9
    s_waitcnt lgkmcnt(4)
    v_mfma_f32_32x32x16_bf16 v[48:63], a[16:19], v[80:83], v[48:63]
    v_sub_f32 v122, -v118, v120
    v_sub_f32 v123, v155, v121
    v_cvt_pk_bf16_f32 v148, v120, v120
    v_cvt_pk_bf16_f32 v149, v122, v121
    v_cvt_pk_bf16_f32 v150, v121, v123
    v_mov_b32 v151, 0
    v_mfma_f32_32x32x16_bf16 v[64:79], a[128:131], v[80:83], v[64:79]
    ds_read_b128 v[100:103], v2 offset:37888
    buffer_load_dwordx4 v[212:215], v2, s[8:11], s51 offen offset:1024 sc1
    v_and_b32 v8, 15, v1
    v_lshlrev_b32 v8, 4, v8
    s_waitcnt lgkmcnt(4)
    v_mfma_f32_32x32x16_bf16 v[48:63], a[20:23], v[84:87], v[48:63]
    v_lshl_add_u32 v8, v4, 8, v8
    v_bfe_u32 v9, v1, 4, 1
    v_lshl_add_u32 v8, v9, 10, v8
    v_mul_f32 v160, v156, v16
    v_mul_f32 v161, v156, v17
    v_mul_f32 v162, v156, v18
    v_mfma_f32_32x32x16_bf16 v[64:79], a[132:135], v[84:87], v[64:79]
    ds_read_b128 v[104:107], v2 offset:38912
    v_mul_f32 v163, v156, v19
    v_exp_f32 v160, v160
    s_waitcnt lgkmcnt(4)
    v_mfma_f32_32x32x16_bf16 v[48:63], a[24:27], v[88:91], v[48:63]
    buffer_load_dwordx4 v[216:219], v2, s[8:11], s51 offen offset:2048 sc1
    v_exp_f32 v161, v161
    v_exp_f32 v162, v162
    v_mfma_f32_32x32x16_bf16 v[64:79], a[136:139], v[88:91], v[64:79]
    ds_read_b128 v[108:111], v2 offset:39936
    v_exp_f32 v163, v163
    v_fma_f32 v160, v160, v152, v152
    v_fma_f32 v161, v161, v152, v152
    s_waitcnt lgkmcnt(4)
    v_mfma_f32_32x32x16_bf16 v[48:63], a[28:31], v[92:95], v[48:63]
    s_add_u32 m0, s43, 0
    s_nop 0
    buffer_load_dwordx4 v2, s[8:11], s52 offen sc1 lds
    v_fma_f32 v162, v162, v152, v152
    v_fma_f32 v163, v163, v152, v152
    v_mfma_f32_32x32x16_bf16 v[64:79], a[140:143], v[92:95], v[64:79]
    ds_read_b128 v[80:83], v2 offset:40960
    v_rcp_f32 v160, v160
    v_rcp_f32 v161, v161
    s_waitcnt lgkmcnt(4)
    v_mfma_f32_32x32x16_bf16 v[48:63], a[32:35], v[96:99], v[48:63]
    v_rcp_f32 v162, v162
    v_rcp_f32 v163, v163
    v_mul_f32 v160, v160, v32
    v_mul_f32 v161, v161, v33
    v_mfma_f32_32x32x16_bf16 v[64:79], a[144:147], v[96:99], v[64:79]
    ds_read_b128 v[84:87], v2 offset:41984
    buffer_load_dwordx4 v[220:223], v2, s[8:11], s51 offen offset:3072 sc1
    s_add_u32 s51, s51, 4096
    v_mul_f32 v162, v162, v34
    s_waitcnt lgkmcnt(4)
    v_mfma_f32_32x32x16_bf16 v[48:63], a[36:39], v[100:103], v[48:63]
    v_mul_f32 v163, v163, v35
    v_cvt_pk_bf16_f32 v168, v160, v161
    v_cvt_pk_bf16_f32 v169, v162, v163
    v_mul_f32 v164, v156, v20
    v_mul_f32 v165, v156, v21
    v_mul_f32 v166, v156, v22
    v_mfma_f32_32x32x16_bf16 v[64:79], a[148:151], v[100:103], v[64:79]
    ds_read_b128 v[88:91], v2 offset:43008
    s_add_u32 m0, s43, 0
    s_nop 0
    buffer_load_dwordx4 v2, s[8:11], s52 offen offset:1024 sc1 lds
    v_mul_f32 v167, v156, v23
    s_waitcnt lgkmcnt(4)
    v_mfma_f32_32x32x16_bf16 v[48:63], a[40:43], v[104:107], v[48:63]
    v_exp_f32 v164, v164
    v_exp_f32 v165, v165
    v_exp_f32 v166, v166
    v_mfma_f32_32x32x16_bf16 v[64:79], a[152:155], v[104:107], v[64:79]
    ds_read_b128 v[92:95], v2 offset:44032
    v_exp_f32 v167, v167
    v_fma_f32 v164, v164, v152, v152
    v_fma_f32 v165, v165, v152, v152
    s_waitcnt lgkmcnt(4)
    v_mfma_f32_32x32x16_bf16 v[48:63], a[44:47], v[108:111], v[48:63]
    buffer_load_dwordx4 v[224:227], v2, s[8:11], s51 offen sc1
    v_fma_f32 v166, v166, v152, v152
    v_fma_f32 v167, v167, v152, v152
    v_rcp_f32 v164, v164
    v_mfma_f32_32x32x16_bf16 v[64:79], a[156:159], v[108:111], v[64:79]
    ds_read_b128 v[96:99], v2 offset:45056
    v_rcp_f32 v165, v165
    v_rcp_f32 v166, v166
    s_waitcnt lgkmcnt(4)
    v_mfma_f32_32x32x16_bf16 v[48:63], a[48:51], v[80:83], v[48:63]
    s_add_u32 m0, s43, 0
    s_nop 0
    buffer_load_dwordx4 v2, s[8:11], s52 offen offset:2048 sc1 lds
    v_rcp_f32 v167, v167
    v_mul_f32 v164, v164, v36
    v_mfma_f32_32x32x16_bf16 v[64:79], a[160:163], v[80:83], v[64:79]
    ds_read_b128 v[100:103], v2 offset:46080
    v_mul_f32 v165, v165, v37
    v_mul_f32 v166, v166, v38
    v_mul_f32 v167, v167, v39
    v_cvt_pk_bf16_f32 v170, v164, v165
    s_waitcnt lgkmcnt(4)
    v_mfma_f32_32x32x16_bf16 v[48:63], a[52:55], v[84:87], v[48:63]
    v_cvt_pk_bf16_f32 v171, v166, v167
    buffer_store_dwordx4 v[168:171], v8, s[8:11], s50 offen sc1
    v_mul_f32 v160, v156, v24
    v_mul_f32 v161, v156, v25
    v_mul_f32 v162, v156, v26
    v_mfma_f32_32x32x16_bf16 v[64:79], a[164:167], v[84:87], v[64:79]
    ds_read_b128 v[104:107], v2 offset:47104
    buffer_load_dwordx4 v[228:231], v2, s[8:11], s51 offen offset:1024 sc1
    v_mul_f32 v163, v156, v27
    s_waitcnt lgkmcnt(4)
    v_mfma_f32_32x32x16_bf16 v[48:63], a[56:59], v[88:91], v[48:63]
    v_exp_f32 v160, v160
    v_exp_f32 v161, v161
    v_exp_f32 v162, v162
    v_mfma_f32_32x32x16_bf16 v[64:79], a[168:171], v[88:91], v[64:79]
    ds_read_b128 v[108:111], v2 offset:48128
    s_add_u32 m0, s43, 0
    s_nop 0
    buffer_load_dwordx4 v2, s[8:11], s52 offen offset:3072 sc1 lds
    s_waitcnt lgkmcnt(4)
    v_mfma_f32_32x32x16_bf16 v[48:63], a[60:63], v[92:95], v[48:63]
    v_exp_f32 v163, v163
    v_fma_f32 v160, v160, v152, v152
    v_fma_f32 v161, v161, v152, v152
    v_fma_f32 v162, v162, v152, v152
    v_fma_f32 v163, v163, v152, v152
    v_mfma_f32_32x32x16_bf16 v[64:79], a[172:175], v[92:95], v[64:79]
    ds_read_b128 v[80:83], v2 offset:49152
    v_rcp_f32 v160, v160
    v_rcp_f32 v161, v161
    s_waitcnt lgkmcnt(4)
    v_mfma_f32_32x32x16_bf16 v[48:63], a[64:67], v[96:99], v[48:63]
    buffer_load_dwordx4 v[232:235], v2, s[8:11], s51 offen offset:2048 sc1
    v_rcp_f32 v162, v162
    v_rcp_f32 v163, v163
    v_mfma_f32_32x32x16_bf16 v[64:79], a[176:179], v[96:99], v[64:79]
    ds_read_b128 v[84:87], v2 offset:50176
    v_mul_f32 v160, v160, v40
    v_mul_f32 v161, v161, v41
    v_mul_f32 v162, v162, v42
    v_mul_f32 v163, v163, v43
    s_waitcnt lgkmcnt(4)
    v_mfma_f32_32x32x16_bf16 v[48:63], a[68:71], v[100:103], v[48:63]
    s_add_u32 m0, s43, 4096
    s_add_u32 s52, s52, 4096
    buffer_load_dwordx4 v2, s[8:11], s52 offen sc1 lds
    v_cvt_pk_bf16_f32 v172, v160, v161
    v_cvt_pk_bf16_f32 v173, v162, v163
    v_mfma_f32_32x32x16_bf16 v[64:79], a[180:183], v[100:103], v[64:79]
    ds_read_b128 v[88:91], v2 offset:51200
    v_mul_f32 v164, v156, v28
    v_mul_f32 v165, v156, v29
    v_mul_f32 v166, v156, v30
    v_mul_f32 v167, v156, v31
    s_waitcnt lgkmcnt(4)
    v_mfma_f32_32x32x16_bf16 v[48:63], a[72:75], v[104:107], v[48:63]
    v_exp_f32 v164, v164
    v_exp_f32 v165, v165
    v_exp_f32 v166, v166
    v_mfma_f32_32x32x16_bf16 v[64:79], a[184:187], v[104:107], v[64:79]
    ds_read_b128 v[92:95], v2 offset:52224
    buffer_load_dwordx4 v[236:239], v2, s[8:11], s51 offen offset:3072 sc1
    s_add_u32 s51, s51, 4096
    s_waitcnt lgkmcnt(4)
    v_mfma_f32_32x32x16_bf16 v[48:63], a[76:79], v[108:111], v[48:63]
    v_exp_f32 v167, v167
    v_fma_f32 v164, v164, v152, v152
    v_fma_f32 v165, v165, v152, v152
    v_fma_f32 v166, v166, v152, v152
    v_fma_f32 v167, v167, v152, v152
    v_mfma_f32_32x32x16_bf16 v[64:79], a[188:191], v[108:111], v[64:79]
    ds_read_b128 v[96:99], v2 offset:53248
    s_add_u32 m0, s43, 4096
    s_nop 0
    buffer_load_dwordx4 v2, s[8:11], s52 offen offset:1024 sc1 lds
    s_waitcnt lgkmcnt(4)
    v_mfma_f32_32x32x16_bf16 v[48:63], a[80:83], v[80:83], v[48:63]
    v_rcp_f32 v164, v164
    v_rcp_f32 v165, v165
    v_rcp_f32 v166, v166
    v_mfma_f32_32x32x16_bf16 v[64:79], a[192:195], v[80:83], v[64:79]
    ds_read_b128 v[100:103], v2 offset:54272
    v_rcp_f32 v167, v167
    v_mul_f32 v164, v164, v44
    v_mul_f32 v165, v165, v45
    s_waitcnt lgkmcnt(4)
    v_mfma_f32_32x32x16_bf16 v[48:63], a[84:87], v[84:87], v[48:63]
    buffer_load_dwordx4 v[240:243], v2, s[8:11], s51 offen sc1
    buffer_load_dword v12, v13, s[8:11], s13 offen sc1
    v_mul_f32 v166, v166, v46
    v_mul_f32 v167, v167, v47
    v_mfma_f32_32x32x16_bf16 v[64:79], a[196:199], v[84:87], v[64:79]
    ds_read_b128 v[104:107], v2 offset:55296
    v_cvt_pk_bf16_f32 v174, v164, v165
    v_cvt_pk_bf16_f32 v175, v166, v167
    buffer_store_dwordx4 v[172:175], v8, s[8:11], s50 offen offset:512 sc1
    s_waitcnt lgkmcnt(4)
    v_mfma_f32_32x32x16_bf16 v[48:63], a[88:91], v[88:91], v[48:63]
    s_add_u32 m0, s43, 4096
    s_nop 0
    buffer_load_dwordx4 v2, s[8:11], s52 offen offset:2048 sc1 lds
    s_add_u32 s50, s50, s57
    v_mfma_f32_32x32x16_bf16 v[64:79], a[200:203], v[88:91], v[64:79]
    ds_read_b128 v[108:111], v2 offset:56320
    s_waitcnt lgkmcnt(4)
    v_mfma_f32_32x32x16_bf16 v[48:63], a[92:95], v[92:95], v[48:63]
    v_mfma_f32_32x32x16_bf16 v[64:79], a[204:207], v[92:95], v[64:79]
    s_waitcnt vmcnt(32)
    s_barrier
    ds_read_b128 v[80:83], v11
    buffer_load_dwordx4 v[244:247], v2, s[8:11], s51 offen offset:1024 sc1
    s_waitcnt lgkmcnt(4)
    v_mfma_f32_32x32x16_bf16 v[48:63], a[96:99], v[96:99], v[48:63]
    v_mfma_f32_32x32x16_bf16 v[64:79], a[208:211], v[96:99], v[64:79]
    ds_read_b128 v[84:87], v11 offset:1024
    s_add_u32 m0, s43, 4096
    s_nop 0
    buffer_load_dwordx4 v2, s[8:11], s52 offen offset:3072 sc1 lds
    s_waitcnt lgkmcnt(4)
    v_mfma_f32_32x32x16_bf16 v[48:63], a[100:103], v[100:103], v[48:63]
    v_mfma_f32_32x32x16_bf16 v[64:79], a[212:215], v[100:103], v[64:79]
    ds_read_b128 v[88:91], v11 offset:2048
    s_waitcnt lgkmcnt(4)
    v_mfma_f32_32x32x16_bf16 v[48:63], a[104:107], v[104:107], v[48:63]
    buffer_load_dwordx4 v[248:251], v2, s[8:11], s51 offen offset:2048 sc1
    v_mfma_f32_32x32x16_bf16 v[64:79], a[216:219], v[104:107], v[64:79]
    ds_read_b128 v[92:95], v11 offset:3072
    s_waitcnt lgkmcnt(4)
    v_mfma_f32_32x32x16_bf16 v[48:63], a[108:111], v[108:111], v[48:63]
    s_add_u32 m0, s43, 8192
    s_add_u32 s52, s52, 4096
    buffer_load_dwordx4 v2, s[8:11], s52 offen sc1 lds
    v_mfma_f32_32x32x16_bf16 v[64:79], a[220:223], v[108:111], v[64:79]
    ds_read_b128 v[96:99], v11 offset:4096
    v_mfma_f32_32x32x16_bf16 v[48:63], v[184:187], v[140:143], v[48:63]
    v_mfma_f32_32x32x16_bf16 v[64:79], v[188:191], v[140:143], v[64:79]
    buffer_load_dwordx4 v[252:255], v2, s[8:11], s51 offen offset:3072 sc1
    s_add_u32 s51, s51, 4096
    s_waitcnt lgkmcnt(4)
    v_mfma_f32_32x32x16_bf16 v[16:31], a[0:3], v[80:83], 0
    v_mfma_f32_32x32x16_bf16 v[32:47], a[112:115], v[80:83], 0
    ds_read_b128 v[100:103], v11 offset:5120
    s_add_u32 m0, s43, 8192
    s_nop 0
    buffer_load_dwordx4 v2, s[8:11], s52 offen offset:1024 sc1 lds
    s_waitcnt lgkmcnt(4)
    v_mfma_f32_32x32x16_bf16 v[16:31], a[4:7], v[84:87], v[16:31]
    v_mfma_f32_32x32x16_bf16 v[32:47], a[116:119], v[84:87], v[32:47]
    ds_read_b128 v[104:107], v11 offset:6144
    v_mul_f32 v160, v157, v48
    v_mul_f32 v161, v157, v49
    v_mul_f32 v162, v157, v50
    v_mul_f32 v163, v157, v51
    s_waitcnt lgkmcnt(4)
    v_mfma_f32_32x32x16_bf16 v[16:31], a[8:11], v[88:91], v[16:31]
    buffer_load_dwordx4 v[176:179], v2, s[8:11], s51 offen sc1
    v_exp_f32 v160, v160
    v_exp_f32 v161, v161
    v_mfma_f32_32x32x16_bf16 v[32:47], a[120:123], v[88:91], v[32:47]
    ds_read_b128 v[108:111], v11 offset:7168
    v_exp_f32 v162, v162
    v_exp_f32 v163, v163
    s_waitcnt lgkmcnt(4)
    v_mfma_f32_32x32x16_bf16 v[16:31], a[12:15], v[92:95], v[16:31]
    s_add_u32 m0, s43, 8192
    s_nop 0
    buffer_load_dwordx4 v2, s[8:11], s52 offen offset:2048 sc1 lds
    v_fma_f32 v160, v160, v153, v153
    v_fma_f32 v161, v161, v153, v153
    v_fma_f32 v162, v162, v153, v153
    v_mfma_f32_32x32x16_bf16 v[32:47], a[124:127], v[92:95], v[32:47]
    ds_read_b128 v[80:83], v11 offset:8192
    v_fma_f32 v163, v163, v153, v153
    v_rcp_f32 v160, v160
    s_waitcnt lgkmcnt(4)
    v_mfma_f32_32x32x16_bf16 v[16:31], a[16:19], v[96:99], v[16:31]
    s_waitcnt vmcnt(29)
    s_barrier
    v_rcp_f32 v161, v161
    v_rcp_f32 v162, v162
    v_mfma_f32_32x32x16_bf16 v[32:47], a[128:131], v[96:99], v[32:47]
    ds_read_b128 v[84:87], v11 offset:9216
    buffer_load_dwordx4 v[180:183], v2, s[8:11], s51 offen offset:1024 sc1
    v_rcp_f32 v163, v163
    s_waitcnt lgkmcnt(4)
    v_mfma_f32_32x32x16_bf16 v[16:31], a[20:23], v[100:103], v[16:31]
    s_waitcnt vmcnt(11)
    v_cmp_gt_u32 vcc, 1, v12
    s_nop 0
    s_and_b32 vcc_lo, vcc_lo, 1
    s_cbranch_scc1 CHK8S
CHK8:
    v_mul_f32 v160, v160, v64
    v_mul_f32 v161, v161, v65
    v_mul_f32 v162, v162, v66
    v_mfma_f32_32x32x16_bf16 v[32:47], a[132:135], v[100:103], v[32:47]
    ds_read_b128 v[88:91], v11 offset:10240
    s_add_u32 m0, s44, 0
    s_nop 0
    buffer_load_dwordx4 v2, s[8:11], s52 offen offset:3072 sc1 lds
    v_mov_b32 v15, 1
    s_waitcnt vmcnt(11)
    buffer_store_dword v15, v13, s[8:11], s39 offen sc1
    s_waitcnt lgkmcnt(4)
    v_mfma_f32_32x32x16_bf16 v[16:31], a[24:27], v[104:107], v[16:31]
    v_mul_f32 v163, v163, v67
    v_cvt_pk_bf16_f32 v168, v160, v161
    v_cvt_pk_bf16_f32 v169, v162, v163
    v_mul_f32 v164, v157, v52
    v_mul_f32 v165, v157, v53
    v_mul_f32 v166, v157, v54
    v_mfma_f32_32x32x16_bf16 v[32:47], a[136:139], v[104:107], v[32:47]
    ds_read_b128 v[92:95], v11 offset:11264
    v_mul_f32 v167, v157, v55
    v_exp_f32 v164, v164
    s_waitcnt lgkmcnt(4)
    v_mfma_f32_32x32x16_bf16 v[16:31], a[28:31], v[108:111], v[16:31]
    buffer_load_dwordx4 v[128:131], v2, s[8:11], s51 offen offset:2048 sc1
    v_exp_f32 v165, v165
    v_exp_f32 v166, v166
    v_mfma_f32_32x32x16_bf16 v[32:47], a[140:143], v[108:111], v[32:47]
    ds_read_b128 v[96:99], v11 offset:12288
    v_exp_f32 v167, v167
    v_fma_f32 v164, v164, v153, v153
    v_fma_f32 v165, v165, v153, v153
    s_waitcnt lgkmcnt(4)
    v_mfma_f32_32x32x16_bf16 v[16:31], a[32:35], v[80:83], v[16:31]
    s_add_u32 m0, s44, 0
    s_add_u32 s52, s52, 4096
    buffer_load_dwordx4 v2, s[8:11], s52 offen sc1 lds
    v_fma_f32 v166, v166, v153, v153
    v_fma_f32 v167, v167, v153, v153
    v_mfma_f32_32x32x16_bf16 v[32:47], a[144:147], v[80:83], v[32:47]
    ds_read_b128 v[100:103], v11 offset:13312
    v_rcp_f32 v164, v164
    v_rcp_f32 v165, v165
    s_waitcnt lgkmcnt(4)
    v_mfma_f32_32x32x16_bf16 v[16:31], a[36:39], v[84:87], v[16:31]
    v_rcp_f32 v166, v166
    v_rcp_f32 v167, v167
    v_mul_f32 v164, v164, v68
    v_mul_f32 v165, v165, v69
    v_mfma_f32_32x32x16_bf16 v[32:47], a[148:151], v[84:87], v[32:47]
    ds_read_b128 v[104:107], v11 offset:14336
    buffer_load_dwordx4 v[132:135], v2, s[8:11], s51 offen offset:3072 sc1
    s_add_u32 s51, s51, 4096
    v_mul_f32 v166, v166, v70
    s_waitcnt lgkmcnt(4)
    v_mfma_f32_32x32x16_bf16 v[16:31], a[40:43], v[88:91], v[16:31]
    v_mul_f32 v167, v167, v71
    v_cvt_pk_bf16_f32 v170, v164, v165
    v_cvt_pk_bf16_f32 v171, v166, v167
    buffer_store_dwordx4 v[168:171], v8, s[8:11], s50 offen sc1
    v_mul_f32 v160, v157, v56
    v_mfma_f32_32x32x16_bf16 v[32:47], a[152:155], v[88:91], v[32:47]
    ds_read_b128 v[108:111], v11 offset:15360
    s_add_u32 m0, s44, 0
    s_nop 0
    buffer_load_dwordx4 v2, s[8:11], s52 offen offset:1024 sc1 lds
    v_mul_f32 v161, v157, v57
    s_waitcnt lgkmcnt(4)
    v_mfma_f32_32x32x16_bf16 v[16:31], a[44:47], v[92:95], v[16:31]
    v_mul_f32 v162, v157, v58
    v_mul_f32 v163, v157, v59
    v_exp_f32 v160, v160
    v_exp_f32 v161, v161
    v_mfma_f32_32x32x16_bf16 v[32:47], a[156:159], v[92:95], v[32:47]
    ds_read_b128 v[80:83], v11 offset:16384
    v_exp_f32 v162, v162
    v_exp_f32 v163, v163
    s_waitcnt lgkmcnt(4)
    v_mfma_f32_32x32x16_bf16 v[16:31], a[48:51], v[96:99], v[16:31]
    buffer_load_dwordx4 v[112:115], v2, s[8:11], s51 offen sc1
    v_fma_f32 v160, v160, v153, v153
    v_fma_f32 v161, v161, v153, v153
    v_fma_f32 v162, v162, v153, v153
    v_fma_f32 v163, v163, v153, v153
    v_mfma_f32_32x32x16_bf16 v[32:47], a[160:163], v[96:99], v[32:47]
    ds_read_b128 v[84:87], v11 offset:17408
    v_rcp_f32 v160, v160
    v_rcp_f32 v161, v161
    s_waitcnt lgkmcnt(4)
    v_mfma_f32_32x32x16_bf16 v[16:31], a[52:55], v[100:103], v[16:31]
    s_add_u32 m0, s44, 0
    s_nop 0
    buffer_load_dwordx4 v2, s[8:11], s52 offen offset:2048 sc1 lds
    v_rcp_f32 v162, v162
    v_mfma_f32_32x32x16_bf16 v[32:47], a[164:167], v[100:103], v[32:47]
    ds_read_b128 v[88:91], v11 offset:18432
    v_rcp_f32 v163, v163
    v_mul_f32 v160, v160, v72
    v_mul_f32 v161, v161, v73
    s_waitcnt lgkmcnt(4)
    v_mfma_f32_32x32x16_bf16 v[16:31], a[56:59], v[104:107], v[16:31]
    v_mul_f32 v162, v162, v74
    v_mul_f32 v163, v163, v75
    v_cvt_pk_bf16_f32 v172, v160, v161
    v_cvt_pk_bf16_f32 v173, v162, v163
    v_mul_f32 v164, v157, v60
    v_mul_f32 v165, v157, v61
    v_mfma_f32_32x32x16_bf16 v[32:47], a[168:171], v[104:107], v[32:47]
    ds_read_b128 v[92:95], v11 offset:19456
    buffer_load_dwordx4 v[116:119], v2, s[8:11], s51 offen offset:1024 sc1
    v_mul_f32 v166, v157, v62
    v_mul_f32 v167, v157, v63
    s_waitcnt lgkmcnt(4)
    v_mfma_f32_32x32x16_bf16 v[16:31], a[60:63], v[108:111], v[16:31]
    v_exp_f32 v164, v164
    v_exp_f32 v165, v165
    v_exp_f32 v166, v166
    v_mfma_f32_32x32x16_bf16 v[32:47], a[172:175], v[108:111], v[32:47]
    ds_read_b128 v[96:99], v11 offset:20480
    s_add_u32 m0, s44, 1024
    s_nop 0
    buffer_load_dwordx4 v2, s[8:11], s52 offen offset:3072 sc1 lds
    s_waitcnt lgkmcnt(4)
    v_mfma_f32_32x32x16_bf16 v[16:31], a[64:67], v[80:83], v[16:31]
    v_exp_f32 v167, v167
    v_fma_f32 v164, v164, v153, v153
    v_fma_f32 v165, v165, v153, v153
    v_fma_f32 v166, v166, v153, v153
    v_fma_f32 v167, v167, v153, v153
    v_mfma_f32_32x32x16_bf16 v[32:47], a[176:179], v[80:83], v[32:47]
    ds_read_b128 v[100:103], v11 offset:21504
    v_rcp_f32 v164, v164
    v_rcp_f32 v165, v165
    s_waitcnt lgkmcnt(4)
    v_mfma_f32_32x32x16_bf16 v[16:31], a[68:71], v[84:87], v[16:31]
    buffer_load_dwordx4 v[120:123], v2, s[8:11], s51 offen offset:2048 sc1
    v_rcp_f32 v166, v166
    v_rcp_f32 v167, v167
    v_mfma_f32_32x32x16_bf16 v[32:47], a[180:183], v[84:87], v[32:47]
    ds_read_b128 v[104:107], v11 offset:22528
    v_mul_f32 v164, v164, v76
    v_mul_f32 v165, v165, v77
    v_mul_f32 v166, v166, v78
    v_mul_f32 v167, v167, v79
    s_waitcnt lgkmcnt(4)
    v_mfma_f32_32x32x16_bf16 v[16:31], a[72:75], v[88:91], v[16:31]
    s_add_u32 m0, s44, 5120
    s_add_u32 s52, s52, 4096
    buffer_load_dwordx4 v2, s[8:11], s52 offen sc1 lds
    v_cvt_pk_bf16_f32 v174, v164, v165
    v_cvt_pk_bf16_f32 v175, v166, v167
    v_mfma_f32_32x32x16_bf16 v[32:47], a[184:187], v[88:91], v[32:47]
    ds_read_b128 v[108:111], v11 offset:23552
    buffer_store_dwordx4 v[172:175], v8, s[8:11], s50 offen offset:512 sc1
    s_add_u32 s50, s50, s37
    s_waitcnt lgkmcnt(4)
    v_mfma_f32_32x32x16_bf16 v[16:31], a[76:79], v[92:95], v[16:31]
    v_mfma_f32_32x32x16_bf16 v[32:47], a[188:191], v[92:95], v[32:47]
    ds_read_b128 v[80:83], v11 offset:24576
    buffer_load_dwordx4 v[124:127], v2, s[8:11], s51 offen offset:3072 sc1
    s_waitcnt lgkmcnt(4)
    v_mfma_f32_32x32x16_bf16 v[16:31], a[80:83], v[96:99], v[16:31]
    v_mfma_f32_32x32x16_bf16 v[32:47], a[192:195], v[96:99], v[32:47]
    ds_read_b128 v[84:87], v11 offset:25600
    s_add_u32 m0, s44, 5120
    s_nop 0
    buffer_load_dwordx4 v2, s[8:11], s52 offen offset:1024 sc1 lds
    s_waitcnt lgkmcnt(4)
    v_mfma_f32_32x32x16_bf16 v[16:31], a[84:87], v[100:103], v[16:31]
    v_mfma_f32_32x32x16_bf16 v[32:47], a[196:199], v[100:103], v[32:47]
    ds_read_b128 v[88:91], v11 offset:26624
    s_waitcnt lgkmcnt(4)
    v_mfma_f32_32x32x16_bf16 v[16:31], a[88:91], v[104:107], v[16:31]
    s_add_u32 m0, s44, 26624
    s_nop 0
    buffer_load_dwordx4 v2, s[8:11], s52 offen offset:2048 sc1 lds
    v_mfma_f32_32x32x16_bf16 v[32:47], a[200:203], v[104:107], v[32:47]
    ds_read_b128 v[92:95], v11 offset:27648
    s_waitcnt lgkmcnt(4)
    v_mfma_f32_32x32x16_bf16 v[16:31], a[92:95], v[108:111], v[16:31]
    s_add_u32 m0, s44, 26624
    s_nop 0
    buffer_load_dwordx4 v2, s[8:11], s52 offen offset:3072 sc1 lds
    buffer_load_dword v14, v6, s[8:11], s12 offen sc1
    v_mfma_f32_32x32x16_bf16 v[32:47], a[204:207], v[108:111], v[32:47]
    ds_read_b128 v[96:99], v11 offset:28672
    s_waitcnt lgkmcnt(4)
    v_mfma_f32_32x32x16_bf16 v[16:31], a[96:99], v[80:83], v[16:31]
    v_mfma_f32_32x32x16_bf16 v[32:47], a[208:211], v[80:83], v[32:47]
    ds_read_b128 v[100:103], v11 offset:29696
    s_add_u32 m0, s44, 30720
    s_add_u32 s52, s52, 4096
    buffer_load_dwordx4 v2, s[8:11], s52 offen sc1 lds
    s_waitcnt lgkmcnt(4)
    v_mfma_f32_32x32x16_bf16 v[16:31], a[100:103], v[84:87], v[16:31]
    v_mfma_f32_32x32x16_bf16 v[32:47], a[212:215], v[84:87], v[32:47]
    ds_read_b128 v[104:107], v11 offset:30720
    s_add_u32 m0, s44, 30720
    s_nop 0
    buffer_load_dwordx4 v2, s[8:11], s52 offen offset:1024 sc1 lds
    s_waitcnt lgkmcnt(4)
    v_mfma_f32_32x32x16_bf16 v[16:31], a[104:107], v[88:91], v[16:31]
    v_mfma_f32_32x32x16_bf16 v[32:47], a[216:219], v[88:91], v[32:47]
    ds_read_b128 v[108:111], v11 offset:31744
    s_waitcnt lgkmcnt(4)
    v_mfma_f32_32x32x16_bf16 v[16:31], a[108:111], v[92:95], v[16:31]
    s_add_u32 m0, s44, 30720
    s_nop 0
    buffer_load_dwordx4 v2, s[8:11], s52 offen offset:2048 sc1 lds
    v_mfma_f32_32x32x16_bf16 v[32:47], a[220:223], v[92:95], v[32:47]
    ds_read_b128 v[80:83], v11 offset:32768
    v_mfma_f32_32x32x16_bf16 v[16:31], v[184:187], v[144:147], v[16:31]
    s_add_u32 m0, s44, 30720
    s_nop 0
    buffer_load_dwordx4 v2, s[8:11], s52 offen offset:3072 sc1 lds
    v_mfma_f32_32x32x16_bf16 v[32:47], v[188:191], v[144:147], v[32:47]
    s_waitcnt lgkmcnt(4)
    v_mfma_f32_32x32x16_bf16 v[48:63], a[0:3], v[96:99], 0
    v_mfma_f32_32x32x16_bf16 v[64:79], a[112:115], v[96:99], 0
    ds_read_b128 v[84:87], v11 offset:33792
    s_add_u32 m0, s44, 34816
    s_add_u32 s52, s52, 4096
    buffer_load_dwordx4 v2, s[8:11], s52 offen sc1 lds
    s_waitcnt lgkmcnt(4)
    v_mfma_f32_32x32x16_bf16 v[48:63], a[4:7], v[100:103], v[48:63]
    v_mfma_f32_32x32x16_bf16 v[64:79], a[116:119], v[100:103], v[64:79]
    ds_read_b128 v[88:91], v11 offset:34816
    v_mul_f32 v160, v158, v16
    v_mul_f32 v161, v158, v17
    v_mul_f32 v162, v158, v18
    v_mul_f32 v163, v158, v19
    s_waitcnt lgkmcnt(4)
    v_mfma_f32_32x32x16_bf16 v[48:63], a[8:11], v[104:107], v[48:63]
    v_exp_f32 v160, v160
    v_exp_f32 v161, v161
    v_exp_f32 v162, v162
    v_mfma_f32_32x32x16_bf16 v[64:79], a[120:123], v[104:107], v[64:79]
    ds_read_b128 v[92:95], v11 offset:35840
    v_exp_f32 v163, v163
    v_fma_f32 v160, v160, v154, v154
    v_fma_f32 v161, v161, v154, v154
    s_waitcnt lgkmcnt(4)
    v_mfma_f32_32x32x16_bf16 v[48:63], a[12:15], v[108:111], v[48:63]
    v_fma_f32 v162, v162, v154, v154
    v_fma_f32 v163, v163, v154, v154
    v_rcp_f32 v160, v160
    v_rcp_f32 v161, v161
    v_mfma_f32_32x32x16_bf16 v[64:79], a[124:127], v[108:111], v[64:79]
    ds_read_b128 v[96:99], v11 offset:36864
    v_rcp_f32 v162, v162
    v_rcp_f32 v163, v163
    s_waitcnt lgkmcnt(4)
    v_mfma_f32_32x32x16_bf16 v[48:63], a[16:19], v[80:83], v[48:63]
    v_mul_f32 v160, v160, v32
    v_mul_f32 v161, v161, v33
    v_mul_f32 v162, v162, v34
    v_mul_f32 v163, v163, v35
    v_cvt_pk_bf16_f32 v168, v160, v161
    v_cvt_pk_bf16_f32 v169, v162, v163
    v_mfma_f32_32x32x16_bf16 v[64:79], a[128:131], v[80:83], v[64:79]
    ds_read_b128 v[100:103], v11 offset:37888
    v_mul_f32 v164, v158, v20
    v_mul_f32 v165, v158, v21
    v_mul_f32 v166, v158, v22
    v_mul_f32 v167, v158, v23
    s_waitcnt lgkmcnt(4)
    v_mfma_f32_32x32x16_bf16 v[48:63], a[20:23], v[84:87], v[48:63]
    v_exp_f32 v164, v164
    v_exp_f32 v165, v165
    v_exp_f32 v166, v166
    v_mfma_f32_32x32x16_bf16 v[64:79], a[132:135], v[84:87], v[64:79]
    ds_read_b128 v[104:107], v11 offset:38912
    v_exp_f32 v167, v167
    v_fma_f32 v164, v164, v154, v154
    v_fma_f32 v165, v165, v154, v154
    s_waitcnt lgkmcnt(4)
    v_mfma_f32_32x32x16_bf16 v[48:63], a[24:27], v[88:91], v[48:63]
    v_fma_f32 v166, v166, v154, v154
    v_fma_f32 v167, v167, v154, v154
    v_rcp_f32 v164, v164
    v_rcp_f32 v165, v165
    v_mfma_f32_32x32x16_bf16 v[64:79], a[136:139], v[88:91], v[64:79]
    ds_read_b128 v[108:111], v11 offset:39936
    v_rcp_f32 v166, v166
    v_rcp_f32 v167, v167
    s_waitcnt lgkmcnt(4)
    v_mfma_f32_32x32x16_bf16 v[48:63], a[28:31], v[92:95], v[48:63]
    s_waitcnt vmcnt(5)
    v_cmp_gt_u32 vcc, 1, v14
    s_nop 0
    s_and_b32 vcc_lo, vcc_lo, 16383
    s_cbranch_scc1 CHK9S
CHK9:
    s_add_u32 s58, s53, s24
    buffer_load_dwordx4 a[0:3], v2, s[8:11], s58 offen sc1
    v_mfma_f32_32x32x16_bf16 v[64:79], a[140:143], v[92:95], v[64:79]
    ds_read_b128 v[80:83], v11 offset:40960
    v_mul_f32 v164, v164, v36
    v_mul_f32 v165, v165, v37
    v_mul_f32 v166, v166, v38
    v_mul_f32 v167, v167, v39
    s_waitcnt lgkmcnt(4)
    v_mfma_f32_32x32x16_bf16 v[48:63], a[32:35], v[96:99], v[48:63]
    buffer_load_dwordx4 a[4:7], v2, s[8:11], s58 offen offset:1024 sc1
    v_cvt_pk_bf16_f32 v170, v164, v165
    v_cvt_pk_bf16_f32 v171, v166, v167
    buffer_store_dwordx4 v[168:171], v8, s[8:11], s50 offen sc1
    v_mfma_f32_32x32x16_bf16 v[64:79], a[144:147], v[96:99], v[64:79]
    ds_read_b128 v[84:87], v11 offset:41984
    v_mul_f32 v160, v158, v24
    v_mul_f32 v161, v158, v25
    v_mul_f32 v162, v158, v26
    v_mul_f32 v163, v158, v27
    s_waitcnt lgkmcnt(4)
    v_mfma_f32_32x32x16_bf16 v[48:63], a[36:39], v[100:103], v[48:63]
    s_add_u32 s58, s53, s25
    buffer_load_dwordx4 a[8:11], v2, s[8:11], s58 offen sc1
    v_exp_f32 v160, v160
    v_mfma_f32_32x32x16_bf16 v[64:79], a[148:151], v[100:103], v[64:79]
    ds_read_b128 v[88:91], v11 offset:43008
    v_exp_f32 v161, v161
    v_exp_f32 v162, v162
    s_waitcnt lgkmcnt(4)
    v_mfma_f32_32x32x16_bf16 v[48:63], a[40:43], v[104:107], v[48:63]
    buffer_load_dwordx4 a[12:15], v2, s[8:11], s58 offen offset:1024 sc1
    v_exp_f32 v163, v163
    v_fma_f32 v160, v160, v154, v154
    v_fma_f32 v161, v161, v154, v154
    v_mfma_f32_32x32x16_bf16 v[64:79], a[152:155], v[104:107], v[64:79]
    ds_read_b128 v[92:95], v11 offset:44032
    v_fma_f32 v162, v162, v154, v154
    v_fma_f32 v163, v163, v154, v154
    v_rcp_f32 v160, v160
    s_waitcnt lgkmcnt(4)
    v_mfma_f32_32x32x16_bf16 v[48:63], a[44:47], v[108:111], v[48:63]
    s_add_u32 s58, s53, s26
    buffer_load_dwordx4 a[16:19], v2, s[8:11], s58 offen sc1
    v_rcp_f32 v161, v161
    v_mfma_f32_32x32x16_bf16 v[64:79], a[156:159], v[108:111], v[64:79]
    ds_read_b128 v[96:99], v11 offset:45056
    v_rcp_f32 v162, v162
    v_rcp_f32 v163, v163
    s_waitcnt lgkmcnt(4)
    v_mfma_f32_32x32x16_bf16 v[48:63], a[48:51], v[80:83], v[48:63]
    v_add_u32 v9, s43, v2
    v_add_u32 v10, s44, v2
    v_mul_f32 v160, v160, v40
    v_mul_f32 v161, v161, v41
    v_mul_f32 v162, v162, v42
    v_mul_f32 v163, v163, v43
    v_mfma_f32_32x32x16_bf16 v[64:79], a[160:163], v[80:83], v[64:79]
    ds_read_b128 v[100:103], v11 offset:46080
    buffer_load_dwordx4 a[20:23], v2, s[8:11], s58 offen offset:1024 sc1
    s_waitcnt vmcnt(7)
    ds_read_b128 a[112:115], v9
    s_waitcnt lgkmcnt(5)
    v_mfma_f32_32x32x16_bf16 v[48:63], a[52:55], v[84:87], v[48:63]
    ds_read_b128 a[116:119], v9 offset:1024
    v_cvt_pk_bf16_f32 v172, v160, v161
    v_cvt_pk_bf16_f32 v173, v162, v163
    v_mul_f32 v164, v158, v28
    v_mul_f32 v165, v158, v29
    v_mul_f32 v166, v158, v30
    v_mfma_f32_32x32x16_bf16 v[64:79], a[164:167], v[84:87], v[64:79]
    ds_read_b128 v[104:107], v11 offset:47104
    s_add_u32 s58, s53, s27
    buffer_load_dwordx4 a[24:27], v2, s[8:11], s58 offen sc1
    ds_read_b128 a[120:123], v9 offset:2048
    s_waitcnt lgkmcnt(7)
    v_mfma_f32_32x32x16_bf16 v[48:63], a[56:59], v[88:91], v[48:63]
    ds_read_b128 a[124:127], v9 offset:3072
    v_mul_f32 v167, v158, v31
    v_exp_f32 v164, v164
    v_exp_f32 v165, v165
    v_mfma_f32_32x32x16_bf16 v[64:79], a[168:171], v[88:91], v[64:79]
    ds_read_b128 v[108:111], v11 offset:48128
    buffer_load_dwordx4 a[28:31], v2, s[8:11], s58 offen offset:1024 sc1
    ds_read_b128 a[128:131], v9 offset:4096
    s_waitcnt lgkmcnt(9)
    v_mfma_f32_32x32x16_bf16 v[48:63], a[60:63], v[92:95], v[48:63]
    ds_read_b128 a[132:135], v9 offset:5120
    v_exp_f32 v166, v166
    v_exp_f32 v167, v167
    v_fma_f32 v164, v164, v154, v154
    v_mfma_f32_32x32x16_bf16 v[64:79], a[172:175], v[92:95], v[64:79]
    ds_read_b128 v[80:83], v11 offset:49152
    s_add_u32 s58, s53, s33
    buffer_load_dwordx4 a[32:35], v2, s[8:11], s58 offen sc1
    ds_read_b128 a[136:139], v9 offset:6144
    s_waitcnt lgkmcnt(11)
    v_mfma_f32_32x32x16_bf16 v[48:63], a[64:67], v[96:99], v[48:63]
    ds_read_b128 a[140:143], v9 offset:7168
    v_fma_f32 v165, v165, v154, v154
    v_fma_f32 v166, v166, v154, v154
    v_fma_f32 v167, v167, v154, v154
    v_rcp_f32 v164, v164
    v_mfma_f32_32x32x16_bf16 v[64:79], a[176:179], v[96:99], v[64:79]
    ds_read_b128 v[84:87], v11 offset:50176
    buffer_load_dwordx4 a[36:39], v2, s[8:11], s58 offen offset:1024 sc1
    ds_read_b128 a[144:147], v9 offset:8192
    s_waitcnt lgkmcnt(13)
    v_mfma_f32_32x32x16_bf16 v[48:63], a[68:71], v[100:103], v[48:63]
    ds_read_b128 a[148:151], v9 offset:9216
    v_rcp_f32 v165, v165
    v_rcp_f32 v166, v166
    v_mfma_f32_32x32x16_bf16 v[64:79], a[180:183], v[100:103], v[64:79]
    ds_read_b128 v[88:91], v11 offset:51200
    ds_read_b128 a[152:155], v9 offset:10240
    v_rcp_f32 v167, v167
    v_mul_f32 v164, v164, v44
    s_waitcnt lgkmcnt(13)
    v_mfma_f32_32x32x16_bf16 v[48:63], a[72:75], v[104:107], v[48:63]
    s_add_u32 s58, s53, s38
    buffer_load_dwordx4 a[40:43], v2, s[8:11], s58 offen sc1
    ds_read_b128 a[156:159], v10 offset:3072
    v_mul_f32 v165, v165, v45
    v_mul_f32 v166, v166, v46
    v_mfma_f32_32x32x16_bf16 v[64:79], a[184:187], v[104:107], v[64:79]
    ds_read_b128 v[92:95], v11 offset:52224
    ds_read_b128 a[160:163], v10
    v_mul_f32 v167, v167, v47
    v_cvt_pk_bf16_f32 v174, v164, v165
    v_cvt_pk_bf16_f32 v175, v166, v167
    s_waitcnt lgkmcnt(13)
    v_mfma_f32_32x32x16_bf16 v[48:63], a[76:79], v[108:111], v[48:63]
    buffer_load_dwordx4 a[44:47], v2, s[8:11], s58 offen offset:1024 sc1
    ds_read_b128 a[164:167], v10 offset:1024
    buffer_store_dwordx4 v[172:175], v8, s[8:11], s50 offen offset:512 sc1
    s_add_u32 s50, s50, s57
    v_mfma_f32_32x32x16_bf16 v[64:79], a[188:191], v[108:111], v[64:79]
    ds_read_b128 v[96:99], v11 offset:53248
    ds_read_b128 a[168:171], v10 offset:2048
    s_waitcnt lgkmcnt(13)
    v_mfma_f32_32x32x16_bf16 v[48:63], a[80:83], v[80:83], v[48:63]
    s_add_u32 s58, s53, s32
    buffer_load_dwordx4 a[48:51], v2, s[8:11], s58 offen sc1
    ds_read_b128 a[172:175], v10 offset:4096
    v_mfma_f32_32x32x16_bf16 v[64:79], a[192:195], v[80:83], v[64:79]
    ds_read_b128 v[100:103], v11 offset:54272
    ds_read_b128 a[176:179], v10 offset:5120
    s_waitcnt lgkmcnt(13)
    v_mfma_f32_32x32x16_bf16 v[48:63], a[84:87], v[84:87], v[48:63]
    buffer_load_dwordx4 a[52:55], v2, s[8:11], s58 offen offset:1024 sc1
    ds_read_b128 a[180:183], v10 offset:6144
    v_mfma_f32_32x32x16_bf16 v[64:79], a[196:199], v[84:87], v[64:79]
    ds_read_b128 v[104:107], v11 offset:55296
    buffer_load_dword v12, v5, s[8:11], s35 offen offset:2044 sc1
    ds_read_b128 a[184:187], v10 offset:28672
    s_waitcnt lgkmcnt(13)
    v_mfma_f32_32x32x16_bf16 v[48:63], a[88:91], v[88:91], v[48:63]
    s_add_u32 s59, s35, s24
    buffer_load_dwordx4 a[56:59], v2, s[8:11], s59 offen sc1
    ds_read_b128 a[188:191], v10 offset:29696
    v_mfma_f32_32x32x16_bf16 v[64:79], a[200:203], v[88:91], v[64:79]
    ds_read_b128 v[108:111], v11 offset:56320
    ds_read_b128 a[192:195], v10 offset:30720
    s_waitcnt lgkmcnt(13)
    v_mfma_f32_32x32x16_bf16 v[48:63], a[92:95], v[92:95], v[48:63]
    buffer_load_dwordx4 a[60:63], v2, s[8:11], s59 offen offset:1024 sc1
    ds_read_b128 a[196:199], v10 offset:31744
    v_mfma_f32_32x32x16_bf16 v[64:79], a[204:207], v[92:95], v[64:79]
    ds_read_b128 a[200:203], v10 offset:32768
    s_waitcnt lgkmcnt(12)
    v_mfma_f32_32x32x16_bf16 v[48:63], a[96:99], v[96:99], v[48:63]
    s_add_u32 s59, s35, s25
    buffer_load_dwordx4 a[64:67], v2, s[8:11], s59 offen sc1
    v_mfma_f32_32x32x16_bf16 v[64:79], a[208:211], v[96:99], v[64:79]
    ds_read_b128 a[204:207], v10 offset:33792
    s_waitcnt lgkmcnt(10)
    v_mfma_f32_32x32x16_bf16 v[48:63], a[100:103], v[100:103], v[48:63]
    buffer_load_dwordx4 a[68:71], v2, s[8:11], s59 offen offset:1024 sc1
    v_mfma_f32_32x32x16_bf16 v[64:79], a[212:215], v[100:103], v[64:79]
    ds_read_b128 a[208:211], v10 offset:34816
    s_waitcnt lgkmcnt(8)
    v_mfma_f32_32x32x16_bf16 v[48:63], a[104:107], v[104:107], v[48:63]
    s_add_u32 s59, s35, s26
    buffer_load_dwordx4 a[72:75], v2, s[8:11], s59 offen sc1
    v_mfma_f32_32x32x16_bf16 v[64:79], a[216:219], v[104:107], v[64:79]
    s_waitcnt lgkmcnt(5)
    v_mfma_f32_32x32x16_bf16 v[48:63], a[108:111], v[108:111], v[48:63]
    v_mfma_f32_32x32x16_bf16 v[64:79], a[220:223], v[108:111], v[64:79]
    buffer_load_dwordx4 a[76:79], v2, s[8:11], s59 offen offset:1024 sc1
    v_mfma_f32_32x32x16_bf16 v[48:63], v[184:187], v[148:151], v[48:63]
    v_mfma_f32_32x32x16_bf16 v[64:79], v[188:191], v[148:151], v[64:79]
    s_add_u32 s59, s35, s27
    buffer_load_dwordx4 a[80:83], v2, s[8:11], s59 offen sc1
    s_waitcnt vmcnt(23)
    v_mfma_f32_16x16x32_bf16 v[16:19], a[224:227], a[0:3], 0
    s_waitcnt vmcnt(20)
    v_mfma_f32_16x16x32_bf16 v[16:19], a[240:243], a[8:11], v[16:19]
    v_mfma_f32_16x16x32_bf16 v[20:23], a[224:227], a[4:7], 0
    buffer_load_dwordx4 a[84:87], v2, s[8:11], s59 offen offset:1024 sc1
    s_waitcnt vmcnt(20)
    v_mfma_f32_16x16x32_bf16 v[20:23], a[240:243], a[12:15], v[20:23]
    v_mfma_f32_16x16x32_bf16 v[24:27], a[228:231], a[0:3], 0
    v_mul_f32 v160, v159, v48
    v_mul_f32 v161, v159, v49
    v_mul_f32 v162, v159, v50
    v_mul_f32 v163, v159, v51
    v_mfma_f32_16x16x32_bf16 v[24:27], a[244:247], a[8:11], v[24:27]
    v_exp_f32 v160, v160
    v_exp_f32 v161, v161
    v_mfma_f32_16x16x32_bf16 v[28:31], a[228:231], a[4:7], 0
    s_add_u32 s59, s35, s33
    buffer_load_dwordx4 a[88:91], v2, s[8:11], s59 offen sc1
    v_mfma_f32_16x16x32_bf16 v[28:31], a[244:247], a[12:15], v[28:31]
    v_exp_f32 v162, v162
    v_exp_f32 v163, v163
    v_fma_f32 v160, v160, v155, v155
    v_mfma_f32_16x16x32_bf16 v[32:35], a[232:235], a[0:3], 0
    v_fma_f32 v161, v161, v155, v155
    v_fma_f32 v162, v162, v155, v155
    v_fma_f32 v163, v163, v155, v155
    v_mfma_f32_16x16x32_bf16 v[32:35], a[248:251], a[8:11], v[32:35]
    v_rcp_f32 v160, v160
    v_rcp_f32 v161, v161
    v_mfma_f32_16x16x32_bf16 v[36:39], a[232:235], a[4:7], 0
    buffer_load_dwordx4 a[92:95], v2, s[8:11], s59 offen offset:1024 sc1
    v_rcp_f32 v162, v162
    v_mfma_f32_16x16x32_bf16 v[36:39], a[248:251], a[12:15], v[36:39]
    v_rcp_f32 v163, v163
    v_mul_f32 v160, v160, v64
    v_mul_f32 v161, v161, v65
    v_mfma_f32_16x16x32_bf16 v[40:43], a[236:239], a[0:3], 0
    v_mul_f32 v162, v162, v66
    v_mul_f32 v163, v163, v67
    v_cvt_pk_bf16_f32 v168, v160, v161
    v_cvt_pk_bf16_f32 v169, v162, v163
    v_mfma_f32_16x16x32_bf16 v[40:43], a[252:255], a[8:11], v[40:43]
    v_mul_f32 v164, v159, v52
    v_mul_f32 v165, v159, v53
    v_mul_f32 v166, v159, v54
    v_mul_f32 v167, v159, v55
    v_mfma_f32_16x16x32_bf16 v[44:47], a[236:239], a[4:7], 0
    v_exp_f32 v164, v164
    v_exp_f32 v165, v165
    v_mfma_f32_16x16x32_bf16 v[44:47], a[252:255], a[12:15], v[44:47]
    v_exp_f32 v166, v166
    v_exp_f32 v167, v167
    s_waitcnt vmcnt(21)
    v_mfma_f32_16x16x32_bf16 v[16:19], v[208:211], a[16:19], v[16:19]
    s_add_u32 s59, s35, s38
    buffer_load_dwordx4 a[96:99], v2, s[8:11], s59 offen sc1
    v_fma_f32 v164, v164, v155, v155
    s_waitcnt vmcnt(20)
    v_mfma_f32_16x16x32_bf16 v[16:19], v[224:227], a[24:27], v[16:19]
    v_fma_f32 v165, v165, v155, v155
    v_fma_f32 v166, v166, v155, v155
    v_fma_f32 v167, v167, v155, v155
    v_mfma_f32_16x16x32_bf16 v[20:23], v[208:211], a[20:23], v[20:23]
    v_rcp_f32 v164, v164
    v_rcp_f32 v165, v165
    s_waitcnt vmcnt(19)
    v_mfma_f32_16x16x32_bf16 v[20:23], v[224:227], a[28:31], v[20:23]
    v_rcp_f32 v166, v166
    v_rcp_f32 v167, v167
    v_mfma_f32_16x16x32_bf16 v[24:27], v[212:215], a[16:19], v[24:27]
    buffer_load_dwordx4 a[100:103], v2, s[8:11], s59 offen offset:1024 sc1
    v_mul_f32 v164, v164, v68
    v_mul_f32 v165, v165, v69
    v_mfma_f32_16x16x32_bf16 v[24:27], v[228:231], a[24:27], v[24:27]
    v_mul_f32 v166, v166, v70
    v_mul_f32 v167, v167, v71
    v_cvt_pk_bf16_f32 v170, v164, v165
    v_cvt_pk_bf16_f32 v171, v166, v167
    v_mfma_f32_16x16x32_bf16 v[28:31], v[212:215], a[20:23], v[28:31]
    buffer_store_dwordx4 v[168:171], v8, s[8:11], s50 offen sc1
    v_mul_f32 v160, v159, v56
    v_mul_f32 v161, v159, v57
    v_mfma_f32_16x16x32_bf16 v[28:31], v[228:231], a[28:31], v[28:31]
    v_mul_f32 v162, v159, v58
    v_mul_f32 v163, v159, v59
    v_exp_f32 v160, v160
    v_mfma_f32_16x16x32_bf16 v[32:35], v[216:219], a[16:19], v[32:35]
    s_add_u32 s59, s35, s32
    buffer_load_dwordx4 a[104:107], v2, s[8:11], s59 offen sc1
    v_mfma_f32_16x16x32_bf16 v[32:35], v[232:235], a[24:27], v[32:35]
    v_exp_f32 v161, v161
    v_exp_f32 v162, v162
    v_mfma_f32_16x16x32_bf16 v[36:39], v[216:219], a[20:23], v[36:39]
    v_exp_f32 v163, v163
    v_fma_f32 v160, v160, v155, v155
    v_fma_f32 v161, v161, v155, v155
    v_mfma_f32_16x16x32_bf16 v[36:39], v[232:235], a[28:31], v[36:39]
    v_fma_f32 v162, v162, v155, v155
    v_fma_f32 v163, v163, v155, v155
    v_rcp_f32 v160, v160
    v_mfma_f32_16x16x32_bf16 v[40:43], v[220:223], a[16:19], v[40:43]
    buffer_load_dwordx4 a[108:111], v2, s[8:11], s59 offen offset:1024 sc1
    v_rcp_f32 v161, v161
    v_mfma_f32_16x16x32_bf16 v[40:43], v[236:239], a[24:27], v[40:43]
    v_rcp_f32 v162, v162
    v_rcp_f32 v163, v163
    v_mfma_f32_16x16x32_bf16 v[44:47], v[220:223], a[20:23], v[44:47]
    v_mul_f32 v160, v160, v72
    v_mul_f32 v161, v161, v73
    v_mul_f32 v162, v162, v74
    v_mul_f32 v163, v163, v75
    v_mfma_f32_16x16x32_bf16 v[44:47], v[236:239], a[28:31], v[44:47]
    v_cvt_pk_bf16_f32 v172, v160, v161
    v_cvt_pk_bf16_f32 v173, v162, v163
    v_mul_f32 v164, v159, v60
    v_mul_f32 v165, v159, v61
    s_waitcnt vmcnt(22)
    v_mfma_f32_16x16x32_bf16 v[16:19], v[240:243], a[32:35], v[16:19]
    buffer_load_dwordx4 a[212:215], v2, s[8:11], s52 offen offset:1024 sc1
    v_mul_f32 v166, v159, v62
    v_mul_f32 v167, v159, v63
    s_waitcnt vmcnt(21)
    v_mfma_f32_16x16x32_bf16 v[16:19], v[176:179], a[40:43], v[16:19]
    v_exp_f32 v164, v164
    v_exp_f32 v165, v165
    s_waitcnt vmcnt(18)
    v_mfma_f32_16x16x32_bf16 v[16:19], v[112:115], a[48:51], v[16:19]
    v_exp_f32 v166, v166
    v_exp_f32 v167, v167
    v_mfma_f32_16x16x32_bf16 v[20:23], v[240:243], a[36:39], v[20:23]
    v_fma_f32 v164, v164, v155, v155
    v_fma_f32 v165, v165, v155, v155
    v_fma_f32 v166, v166, v155, v155
    v_fma_f32 v167, v167, v155, v155
    v_mfma_f32_16x16x32_bf16 v[20:23], v[176:179], a[44:47], v[20:23]
    v_rcp_f32 v164, v164
    v_rcp_f32 v165, v165
    s_waitcnt vmcnt(17)
    v_mfma_f32_16x16x32_bf16 v[20:23], v[112:115], a[52:55], v[20:23]
    v_rcp_f32 v166, v166
    v_rcp_f32 v167, v167
    v_mfma_f32_16x16x32_bf16 v[24:27], v[244:247], a[32:35], v[24:27]
    buffer_load_dwordx4 a[216:219], v2, s[8:11], s52 offen offset:2048 sc1
    v_mul_f32 v164, v164, v76
    v_mul_f32 v165, v165, v77
    v_mfma_f32_16x16x32_bf16 v[24:27], v[180:183], a[40:43], v[24:27]
    v_mul_f32 v166, v166, v78
    v_mul_f32 v167, v167, v79
    v_cvt_pk_bf16_f32 v174, v164, v165
    v_cvt_pk_bf16_f32 v175, v166, v167
    v_mfma_f32_16x16x32_bf16 v[24:27], v[116:119], a[48:51], v[24:27]
    buffer_store_dwordx4 v[172:175], v8, s[8:11], s50 offen offset:512 sc1
    v_mfma_f32_16x16x32_bf16 v[28:31], v[244:247], a[36:39], v[28:31]
    v_mfma_f32_16x16x32_bf16 v[28:31], v[180:183], a[44:47], v[28:31]
    buffer_load_dwordx4 a[220:223], v2, s[8:11], s52 offen offset:3072 sc1
    v_mfma_f32_16x16x32_bf16 v[28:31], v[116:119], a[52:55], v[28:31]
    v_mfma_f32_16x16x32_bf16 v[32:35], v[248:251], a[32:35], v[32:35]
    v_mfma_f32_16x16x32_bf16 v[32:35], v[128:131], a[40:43], v[32:35]
    v_mfma_f32_16x16x32_bf16 v[32:35], v[120:123], a[48:51], v[32:35]
    v_mfma_f32_16x16x32_bf16 v[36:39], v[248:251], a[36:39], v[36:39]
    v_mfma_f32_16x16x32_bf16 v[36:39], v[128:131], a[44:47], v[36:39]
    v_mfma_f32_16x16x32_bf16 v[36:39], v[120:123], a[52:55], v[36:39]
    v_mfma_f32_16x16x32_bf16 v[40:43], v[252:255], a[32:35], v[40:43]
    v_mfma_f32_16x16x32_bf16 v[40:43], v[132:135], a[40:43], v[40:43]
    v_mfma_f32_16x16x32_bf16 v[40:43], v[124:127], a[48:51], v[40:43]
    v_add_u32 v10, s15, v2
    v_xor_b32 v9, 8192, v10
    v_mfma_f32_16x16x32_bf16 v[44:47], v[252:255], a[36:39], v[44:47]
    v_xor_b32 v11, 16384, v10
    v_xor_b32 v13, 24576, v10
    v_mfma_f32_16x16x32_bf16 v[44:47], v[132:135], a[44:47], v[44:47]
    v_mfma_f32_16x16x32_bf16 v[44:47], v[124:127], a[52:55], v[44:47]
    s_waitcnt vmcnt(19)
    v_cmp_eq_u32 vcc, -1, v12
    s_nop 0
    s_cbranch_vccnz SLOWS2
BACKS2:
    v_and_b32 v6, 48, v1
    s_waitcnt vmcnt(18)
    v_mfma_f32_16x16x32_bf16 v[80:83], a[112:115], a[56:59], v[16:19]
    buffer_load_dwordx4 v[160:163], v6, s[8:11], s5 offen sc1
    s_waitcnt vmcnt(17)
    v_mfma_f32_16x16x32_bf16 v[80:83], a[128:131], a[64:67], v[80:83]
    v_mul_u32_u24 v7, 57344, v3
    v_lshl_add_u32 v8, v4, 4, v7
    v_mfma_f32_16x16x32_bf16 v[84:87], a[112:115], a[60:63], v[20:23]
    s_add_u32 s53, s53, 229376
    s_waitcnt vmcnt(16)
    v_mfma_f32_16x16x32_bf16 v[84:87], a[128:131], a[68:71], v[84:87]
    buffer_load_dword v14, v5, s[8:11], s53 offen offset:2044 sc1
    v_add_u32 v7, s54, v2
    v_mfma_f32_16x16x32_bf16 v[88:91], a[116:119], a[56:59], v[24:27]
    s_add_u32 s58, s53, s24
    v_mfma_f32_16x16x32_bf16 v[88:91], a[132:135], a[64:67], v[88:91]
    buffer_load_dwordx4 a[0:3], v2, s[8:11], s58 offen sc1
    v_mfma_f32_16x16x32_bf16 v[92:95], a[116:119], a[60:63], v[28:31]
    v_mfma_f32_16x16x32_bf16 v[92:95], a[132:135], a[68:71], v[92:95]
    v_mfma_f32_16x16x32_bf16 v[96:99], a[120:123], a[56:59], v[32:35]
    buffer_load_dwordx4 a[4:7], v2, s[8:11], s58 offen offset:1024 sc1
    v_mfma_f32_16x16x32_bf16 v[96:99], a[136:139], a[64:67], v[96:99]
    v_mfma_f32_16x16x32_bf16 v[100:103], a[120:123], a[60:63], v[36:39]
    v_mfma_f32_16x16x32_bf16 v[100:103], a[136:139], a[68:71], v[100:103]
    v_mfma_f32_16x16x32_bf16 v[104:107], a[124:127], a[56:59], v[40:43]
    s_add_u32 s58, s53, s25
    v_mfma_f32_16x16x32_bf16 v[104:107], a[140:143], a[64:67], v[104:107]
    buffer_load_dwordx4 a[8:11], v2, s[8:11], s58 offen sc1
    v_mfma_f32_16x16x32_bf16 v[108:111], a[124:127], a[60:63], v[44:47]
    v_mfma_f32_16x16x32_bf16 v[108:111], a[140:143], a[68:71], v[108:111]
    s_waitcnt vmcnt(19)
    v_mfma_f32_16x16x32_bf16 v[80:83], a[144:147], a[72:75], v[80:83]
    buffer_load_dwordx4 a[12:15], v2, s[8:11], s58 offen offset:1024 sc1
    s_waitcnt vmcnt(18)
    v_mfma_f32_16x16x32_bf16 v[80:83], a[160:163], a[80:83], v[80:83]
    v_mfma_f32_16x16x32_bf16 v[84:87], a[144:147], a[76:79], v[84:87]
    s_waitcnt vmcnt(17)
    v_mfma_f32_16x16x32_bf16 v[84:87], a[160:163], a[84:87], v[84:87]
    v_mfma_f32_16x16x32_bf16 v[88:91], a[148:151], a[72:75], v[88:91]
    s_add_u32 s58, s53, s26
    v_mfma_f32_16x16x32_bf16 v[88:91], a[164:167], a[80:83], v[88:91]
    buffer_load_dwordx4 a[16:19], v2, s[8:11], s58 offen sc1
    v_mfma_f32_16x16x32_bf16 v[92:95], a[148:151], a[76:79], v[92:95]
    v_mfma_f32_16x16x32_bf16 v[92:95], a[164:167], a[84:87], v[92:95]
    v_mfma_f32_16x16x32_bf16 v[96:99], a[152:155], a[72:75], v[96:99]
    buffer_load_dwordx4 a[20:23], v2, s[8:11], s58 offen offset:1024 sc1
    v_mfma_f32_16x16x32_bf16 v[96:99], a[168:171], a[80:83], v[96:99]
    v_mfma_f32_16x16x32_bf16 v[100:103], a[152:155], a[76:79], v[100:103]
    v_mfma_f32_16x16x32_bf16 v[100:103], a[168:171], a[84:87], v[100:103]
    v_mfma_f32_16x16x32_bf16 v[104:107], a[156:159], a[72:75], v[104:107]
    s_add_u32 s58, s53, s27
    v_mfma_f32_16x16x32_bf16 v[104:107], a[172:175], a[80:83], v[104:107]
    buffer_load_dwordx4 a[24:27], v2, s[8:11], s58 offen sc1
    v_mfma_f32_16x16x32_bf16 v[108:111], a[156:159], a[76:79], v[108:111]
    v_mfma_f32_16x16x32_bf16 v[108:111], a[172:175], a[84:87], v[108:111]
    s_waitcnt vmcnt(19)
    v_mfma_f32_16x16x32_bf16 v[80:83], a[176:179], a[88:91], v[80:83]
    buffer_load_dwordx4 a[28:31], v2, s[8:11], s58 offen offset:1024 sc1
    s_waitcnt vmcnt(18) lgkmcnt(4)
    v_mfma_f32_16x16x32_bf16 v[80:83], a[192:195], a[96:99], v[80:83]
    s_waitcnt vmcnt(15) lgkmcnt(0)
    v_mfma_f32_16x16x32_bf16 v[80:83], a[208:211], a[104:107], v[80:83]
    v_mfma_f32_16x16x32_bf16 v[84:87], a[176:179], a[92:95], v[84:87]
    v_mfma_f32_16x16x32_bf16 v[84:87], a[192:195], a[100:103], v[84:87]
    s_add_u32 s58, s53, s33
    buffer_load_dwordx4 a[32:35], v2, s[8:11], s58 offen sc1
    s_waitcnt vmcnt(15)
    v_mfma_f32_16x16x32_bf16 v[84:87], a[208:211], a[108:111], v[84:87]
    s_waitcnt lgkmcnt(0)
    s_barrier
    v_mfma_f32_16x16x32_bf16 v[88:91], a[180:183], a[88:91], v[88:91]
    ds_write_b128 v7, v[192:195]
    v_mfma_f32_16x16x32_bf16 v[88:91], a[196:199], a[96:99], v[88:91]
    s_waitcnt vmcnt(14)
    v_mfma_f32_16x16x32_bf16 v[88:91], a[212:215], a[104:107], v[88:91]
    buffer_load_dwordx4 a[36:39], v2, s[8:11], s58 offen offset:1024 sc1
    v_mfma_f32_16x16x32_bf16 v[92:95], a[180:183], a[92:95], v[92:95]
    v_mfma_f32_16x16x32_bf16 v[92:95], a[196:199], a[100:103], v[92:95]
    ds_write_b128 v7, v[196:199] offset:1024
    v_mfma_f32_16x16x32_bf16 v[92:95], a[212:215], a[108:111], v[92:95]
    v_mfma_f32_16x16x32_bf16 v[96:99], a[184:187], a[88:91], v[96:99]
    s_add_u32 s58, s53, s38
    v_mfma_f32_16x16x32_bf16 v[96:99], a[200:203], a[96:99], v[96:99]
    buffer_load_dwordx4 a[40:43], v2, s[8:11], s58 offen sc1
    s_waitcnt vmcnt(15)
    v_mfma_f32_16x16x32_bf16 v[96:99], a[216:219], a[104:107], v[96:99]
    ds_write_b128 v7, v[200:203] offset:2048
    v_mfma_f32_16x16x32_bf16 v[100:103], a[184:187], a[92:95], v[100:103]
    v_mfma_f32_16x16x32_bf16 v[100:103], a[200:203], a[100:103], v[100:103]
    buffer_load_dwordx4 a[44:47], v2, s[8:11], s58 offen offset:1024 sc1
    v_mfma_f32_16x16x32_bf16 v[100:103], a[216:219], a[108:111], v[100:103]
    v_mfma_f32_16x16x32_bf16 v[104:107], a[188:191], a[88:91], v[104:107]
    ds_write_b128 v7, v[204:207] offset:3072
    v_mfma_f32_16x16x32_bf16 v[104:107], a[204:207], a[96:99], v[104:107]
    s_waitcnt vmcnt(14)
    v_mfma_f32_16x16x32_bf16 v[104:107], a[220:223], a[104:107], v[104:107]
    s_add_u32 s58, s53, s32
    v_mfma_f32_16x16x32_bf16 v[108:111], a[188:191], a[92:95], v[108:111]
    buffer_load_dwordx4 a[48:51], v2, s[8:11], s58 offen sc1
    v_and_b32 v15, 15, v1
    v_mfma_f32_16x16x32_bf16 v[108:111], a[204:207], a[100:103], v[108:111]
    v_mfma_f32_16x16x32_bf16 v[108:111], a[220:223], a[108:111], v[108:111]
    s_waitcnt vmcnt(13)
    v_cmp_eq_u32 vcc, -1, v14
    s_nop 0
    s_cbranch_vccnz SLOWS3
BACKS3:
    s_waitcnt vmcnt(12)
    v_mfma_f32_16x16x32_bf16 v[48:51], a[224:227], a[0:3], 0
    buffer_load_dwordx4 a[52:55], v2, s[8:11], s58 offen offset:1024 sc1
    s_waitcnt vmcnt(11)
    v_mfma_f32_16x16x32_bf16 v[48:51], a[240:243], a[8:11], v[48:51]
    v_lshlrev_b32 v15, 4, v15
    v_lshl_add_u32 v15, v6, 5, v15
    v_mfma_f32_16x16x32_bf16 v[52:55], a[224:227], a[4:7], 0
    v_add_u32 v7, s46, v15
    s_waitcnt vmcnt(10)
    v_mfma_f32_16x16x32_bf16 v[52:55], a[240:243], a[12:15], v[52:55]
    v_mfma_f32_16x16x32_bf16 v[56:59], a[228:231], a[0:3], 0
    v_mfma_f32_16x16x32_bf16 v[56:59], a[244:247], a[8:11], v[56:59]
    v_mfma_f32_16x16x32_bf16 v[60:63], a[228:231], a[4:7], 0
    v_mfma_f32_16x16x32_bf16 v[60:63], a[244:247], a[12:15], v[60:63]
    v_cmp_u_f32 vcc, v80, v84
    s_nop 0
    s_cbranch_vccnz SLOWN0
BACKN0:
    v_mfma_f32_16x16x32_bf16 v[64:67], a[232:235], a[0:3], 0
    s_add_u32 s35, s35, 229376
    v_mfma_f32_16x16x32_bf16 v[64:67], a[248:251], a[8:11], v[64:67]
    buffer_load_dword v12, v5, s[8:11], s35 offen offset:2044 sc1
    v_mfma_f32_16x16x32_bf16 v[68:71], a[232:235], a[4:7], 0
    s_add_u32 s59, s35, s24
    v_mfma_f32_16x16x32_bf16 v[68:71], a[248:251], a[12:15], v[68:71]
    buffer_load_dwordx4 a[56:59], v2, s[8:11], s59 offen sc1
    ds_write_b128 v13, v[80:83] offset:6144
    v_mfma_f32_16x16x32_bf16 v[72:75], a[236:239], a[0:3], 0
    buffer_load_dwordx4 a[60:63], v2, s[8:11], s59 offen offset:1024 sc1
    v_mfma_f32_16x16x32_bf16 v[72:75], a[252:255], a[8:11], v[72:75]
    v_mfma_f32_16x16x32_bf16 v[76:79], a[236:239], a[4:7], 0
    ds_write_b128 v13, v[84:87] offset:7168
    v_mfma_f32_16x16x32_bf16 v[76:79], a[252:255], a[12:15], v[76:79]
    s_waitcnt vmcnt(12)
    v_mfma_f32_16x16x32_bf16 v[48:51], v[208:211], a[16:19], v[48:51]
    s_add_u32 s59, s35, s25
    s_waitcnt vmcnt(10)
    v_mfma_f32_16x16x32_bf16 v[48:51], v[224:227], a[24:27], v[48:51]
    buffer_load_dwordx4 a[64:67], v2, s[8:11], s59 offen sc1
    v_mfma_f32_16x16x32_bf16 v[52:55], v[208:211], a[20:23], v[52:55]
    buffer_load_dwordx4 a[68:71], v2, s[8:11], s59 offen offset:1024 sc1
    s_waitcnt vmcnt(11)
    v_mfma_f32_16x16x32_bf16 v[52:55], v[224:227], a[28:31], v[52:55]
    ds_write_b128 v9, v[88:91] offset:2048
    v_mfma_f32_16x16x32_bf16 v[56:59], v[212:215], a[16:19], v[56:59]
    v_mfma_f32_16x16x32_bf16 v[56:59], v[228:231], a[24:27], v[56:59]
    v_mfma_f32_16x16x32_bf16 v[60:63], v[212:215], a[20:23], v[60:63]
    s_add_u32 s59, s35, s26
    v_mfma_f32_16x16x32_bf16 v[60:63], v[228:231], a[28:31], v[60:63]
    buffer_load_dwordx4 a[72:75], v2, s[8:11], s59 offen sc1
    ds_write_b128 v9, v[92:95] offset:3072
    v_mfma_f32_16x16x32_bf16 v[64:67], v[216:219], a[16:19], v[64:67]
    buffer_load_dwordx4 a[76:79], v2, s[8:11], s59 offen offset:1024 sc1
    v_mfma_f32_16x16x32_bf16 v[64:67], v[232:235], a[24:27], v[64:67]
    v_mfma_f32_16x16x32_bf16 v[68:71], v[216:219], a[20:23], v[68:71]
    ds_write_b128 v11, v[96:99] offset:4096
    v_mfma_f32_16x16x32_bf16 v[68:71], v[232:235], a[28:31], v[68:71]
    v_mfma_f32_16x16x32_bf16 v[72:75], v[220:223], a[16:19], v[72:75]
    s_add_u32 s59, s35, s27
    v_mfma_f32_16x16x32_bf16 v[72:75], v[236:239], a[24:27], v[72:75]
    buffer_load_dwordx4 a[80:83], v2, s[8:11], s59 offen sc1
    v_mfma_f32_16x16x32_bf16 v[76:79], v[220:223], a[20:23], v[76:79]
    buffer_load_dwordx4 a[84:87], v2, s[8:11], s59 offen offset:1024 sc1
    v_mfma_f32_16x16x32_bf16 v[76:79], v[236:239], a[28:31], v[76:79]
    ds_write_b128 v11, v[100:103] offset:5120
    s_waitcnt vmcnt(14)
    v_mfma_f32_16x16x32_bf16 v[48:51], v[240:243], a[32:35], v[48:51]
    s_waitcnt vmcnt(12)
    v_mfma_f32_16x16x32_bf16 v[48:51], v[176:179], a[40:43], v[48:51]
    s_waitcnt vmcnt(10)
    v_mfma_f32_16x16x32_bf16 v[48:51], v[112:115], a[48:51], v[48:51]
    s_add_u32 s59, s35, s33
    v_mfma_f32_16x16x32_bf16 v[52:55], v[240:243], a[36:39], v[52:55]
    buffer_load_dwordx4 a[88:91], v2, s[8:11], s59 offen sc1
    v_mfma_f32_16x16x32_bf16 v[52:55], v[176:179], a[44:47], v[52:55]
    buffer_load_dwordx4 a[92:95], v2, s[8:11], s59 offen offset:1024 sc1
    s_waitcnt vmcnt(11)
    v_mfma_f32_16x16x32_bf16 v[52:55], v[112:115], a[52:55], v[52:55]
    v_mfma_f32_16x16x32_bf16 v[56:59], v[244:247], a[32:35], v[56:59]
    v_mfma_f32_16x16x32_bf16 v[56:59], v[180:183], a[40:43], v[56:59]
    v_mfma_f32_16x16x32_bf16 v[56:59], v[116:119], a[48:51], v[56:59]
    s_add_u32 s59, s35, s38
    v_mfma_f32_16x16x32_bf16 v[60:63], v[244:247], a[36:39], v[60:63]
    buffer_load_dwordx4 a[96:99], v2, s[8:11], s59 offen sc1
    v_mfma_f32_16x16x32_bf16 v[60:63], v[180:183], a[44:47], v[60:63]
    buffer_load_dwordx4 a[100:103], v2, s[8:11], s59 offen offset:1024 sc1
    v_mfma_f32_16x16x32_bf16 v[60:63], v[116:119], a[52:55], v[60:63]
    v_mfma_f32_16x16x32_bf16 v[64:67], v[248:251], a[32:35], v[64:67]
    v_mfma_f32_16x16x32_bf16 v[64:67], v[128:131], a[40:43], v[64:67]
    v_min3_u32 v15, v160, v161, v162
    v_min_u32 v15, v15, v163
    v_cmp_eq_u32 vcc, 0, v15
    s_nop 0
    s_cbranch_vccnz SLOWG
BACKG:
    v_mfma_f32_16x16x32_bf16 v[64:67], v[120:123], a[48:51], v[64:67]
    s_add_u32 s59, s35, s32
    v_mfma_f32_16x16x32_bf16 v[68:71], v[248:251], a[36:39], v[68:71]
    buffer_load_dwordx4 a[104:107], v2, s[8:11], s59 offen sc1
    v_mfma_f32_16x16x32_bf16 v[68:71], v[128:131], a[44:47], v[68:71]
    buffer_load_dwordx4 a[108:111], v2, s[8:11], s59 offen offset:1024 sc1
    v_mfma_f32_16x16x32_bf16 v[68:71], v[120:123], a[52:55], v[68:71]
    s_waitcnt lgkmcnt(0)
    s_barrier
    v_mfma_f32_16x16x32_bf16 v[72:75], v[252:255], a[32:35], v[72:75]
    ds_read_b128 v[192:195], v7
    ds_read_b128 v[196:199], v7 offset:256
    v_mfma_f32_16x16x32_bf16 v[72:75], v[132:135], a[40:43], v[72:75]
    ds_read_b128 v[200:203], v7 offset:8192
    v_mfma_f32_16x16x32_bf16 v[72:75], v[124:127], a[48:51], v[72:75]
    ds_read_b128 v[204:207], v7 offset:8448
    ds_read_b128 v[16:19], v10 offset:2048
    v_mfma_f32_16x16x32_bf16 v[76:79], v[252:255], a[36:39], v[76:79]
    ds_read_b128 v[20:23], v10 offset:3072
    v_mfma_f32_16x16x32_bf16 v[76:79], v[132:135], a[44:47], v[76:79]
    ds_read_b128 v[24:27], v10 offset:4096
    ds_read_b128 v[28:31], v10 offset:5120
    ds_read_b128 v[32:35], v10 offset:6144
    v_mfma_f32_16x16x32_bf16 v[76:79], v[124:127], a[52:55], v[76:79]
    s_waitcnt vmcnt(14)
    v_cmp_eq_u32 vcc, -1, v12
    s_nop 0
    s_cbranch_vccnz SLOWS4
BACKS4:
    s_waitcnt vmcnt(13)
    v_mfma_f32_16x16x32_bf16 v[48:51], a[112:115], a[56:59], v[48:51]
    ds_read_b128 v[36:39], v10 offset:7168
    s_waitcnt vmcnt(11)
    v_mfma_f32_16x16x32_bf16 v[48:51], a[128:131], a[64:67], v[48:51]
    v_mfma_f32_16x16x32_bf16 v[52:55], a[112:115], a[60:63], v[52:55]
    s_waitcnt vmcnt(10)
    v_mfma_f32_16x16x32_bf16 v[52:55], a[128:131], a[68:71], v[52:55]
    v_mfma_f32_16x16x32_bf16 v[56:59], a[116:119], a[56:59], v[56:59]
    v_mfma_f32_16x16x32_bf16 v[56:59], a[132:135], a[64:67], v[56:59]
    v_mfma_f32_16x16x32_bf16 v[60:63], a[116:119], a[60:63], v[60:63]
    s_waitcnt lgkmcnt(9)
    v_fmac_f32 v192, v160, v104
    v_fmac_f32 v193, v161, v105
    v_mfma_f32_16x16x32_bf16 v[60:63], a[132:135], a[68:71], v[60:63]
    v_fmac_f32 v194, v162, v106
    v_fmac_f32 v195, v163, v107
    v_mfma_f32_16x16x32_bf16 v[64:67], a[120:123], a[56:59], v[64:67]
    s_waitcnt lgkmcnt(8)
    v_fmac_f32 v196, v160, v108
    v_fmac_f32 v197, v161, v109
    v_mfma_f32_16x16x32_bf16 v[64:67], a[136:139], a[64:67], v[64:67]
    v_fmac_f32 v198, v162, v110
    v_fmac_f32 v199, v163, v111
    v_mfma_f32_16x16x32_bf16 v[68:71], a[120:123], a[60:63], v[68:71]
    s_waitcnt lgkmcnt(3)
    v_add_f32 v16, v16, v24
    v_add_f32 v17, v17, v25
    v_mfma_f32_16x16x32_bf16 v[68:71], a[136:139], a[68:71], v[68:71]
    v_add_f32 v18, v18, v26
    v_add_f32 v19, v19, v27
    v_mfma_f32_16x16x32_bf16 v[72:75], a[124:127], a[56:59], v[72:75]
    s_waitcnt lgkmcnt(2)
    v_add_f32 v20, v20, v28
    v_add_f32 v21, v21, v29
    v_mfma_f32_16x16x32_bf16 v[72:75], a[140:143], a[64:67], v[72:75]
    v_add_f32 v22, v22, v30
    v_add_f32 v23, v23, v31
    v_mfma_f32_16x16x32_bf16 v[76:79], a[124:127], a[60:63], v[76:79]
    s_waitcnt lgkmcnt(1)
    v_add_f32 v16, v16, v32
    v_add_f32 v17, v17, v33
    v_mfma_f32_16x16x32_bf16 v[76:79], a[140:143], a[68:71], v[76:79]
    v_add_f32 v18, v18, v34
    v_add_f32 v19, v19, v35
    s_waitcnt vmcnt(9)
    v_mfma_f32_16x16x32_bf16 v[48:51], a[144:147], a[72:75], v[48:51]
    s_waitcnt lgkmcnt(0)
    v_add_f32 v20, v20, v36
    v_add_f32 v21, v21, v37
    s_waitcnt vmcnt(7)
    v_mfma_f32_16x16x32_bf16 v[48:51], a[160:163], a[80:83], v[48:51]
    v_add_f32 v22, v22, v38
    v_add_f32 v23, v23, v39
    v_mfma_f32_16x16x32_bf16 v[52:55], a[144:147], a[76:79], v[52:55]
    v_fmac_f32 v192, v160, v16
    v_fmac_f32 v193, v161, v17
    s_waitcnt vmcnt(6)
    v_mfma_f32_16x16x32_bf16 v[52:55], a[160:163], a[84:87], v[52:55]
    v_fmac_f32 v194, v162, v18
    v_fmac_f32 v195, v163, v19
    v_mfma_f32_16x16x32_bf16 v[56:59], a[148:151], a[72:75], v[56:59]
    v_fmac_f32 v196, v160, v20
    v_fmac_f32 v197, v161, v21
    v_mfma_f32_16x16x32_bf16 v[56:59], a[164:167], a[80:83], v[56:59]
    v_fmac_f32 v198, v162, v22
    v_fmac_f32 v199, v163, v23
    v_mfma_f32_16x16x32_bf16 v[60:63], a[148:151], a[76:79], v[60:63]
    v_cvt_pk_bf16_f32 v168, v192, v193
    v_cvt_pk_bf16_f32 v170, v196, v197
    v_mfma_f32_16x16x32_bf16 v[60:63], a[164:167], a[84:87], v[60:63]
    v_cvt_pk_bf16_f32 v169, v194, v195
    v_cvt_pk_bf16_f32 v171, v198, v199
    v_mfma_f32_16x16x32_bf16 v[64:67], a[152:155], a[72:75], v[64:67]
    v_permlane16_swap_b32 v168, v170
    v_permlane16_swap_b32 v169, v171
    v_mfma_f32_16x16x32_bf16 v[64:67], a[168:171], a[80:83], v[64:67]
    buffer_store_dwordx4 v[168:171], v8, s[20:23], s6 offen
    v_mfma_f32_16x16x32_bf16 v[68:71], a[152:155], a[76:79], v[68:71]
    v_mfma_f32_16x16x32_bf16 v[68:71], a[168:171], a[84:87], v[68:71]
    v_mfma_f32_16x16x32_bf16 v[72:75], a[156:159], a[72:75], v[72:75]
    v_mfma_f32_16x16x32_bf16 v[72:75], a[172:175], a[80:83], v[72:75]
    v_mfma_f32_16x16x32_bf16 v[76:79], a[156:159], a[76:79], v[76:79]
    v_mfma_f32_16x16x32_bf16 v[76:79], a[172:175], a[84:87], v[76:79]
    s_waitcnt vmcnt(6)
    v_mfma_f32_16x16x32_bf16 v[48:51], a[176:179], a[88:91], v[48:51]
    s_waitcnt vmcnt(4)
    v_mfma_f32_16x16x32_bf16 v[48:51], a[192:195], a[96:99], v[48:51]
    s_waitcnt vmcnt(2)
    v_mfma_f32_16x16x32_bf16 v[48:51], a[208:211], a[104:107], v[48:51]
    v_mfma_f32_16x16x32_bf16 v[52:55], a[176:179], a[92:95], v[52:55]
    v_mfma_f32_16x16x32_bf16 v[52:55], a[192:195], a[100:103], v[52:55]
    s_waitcnt vmcnt(1)
    v_mfma_f32_16x16x32_bf16 v[52:55], a[208:211], a[108:111], v[52:55]
    v_mfma_f32_16x16x32_bf16 v[56:59], a[180:183], a[88:91], v[56:59]
    s_nop 1
    v_mfma_f32_16x16x32_bf16 v[56:59], a[196:199], a[96:99], v[56:59]
    s_nop 1
    v_mfma_f32_16x16x32_bf16 v[56:59], a[212:215], a[104:107], v[56:59]
    ds_write_b128 v13, v[48:51] offset:38912
    s_nop 0
    v_mfma_f32_16x16x32_bf16 v[60:63], a[180:183], a[92:95], v[60:63]
    ds_write_b128 v13, v[52:55] offset:39936
    v_mfma_f32_16x16x32_bf16 v[60:63], a[196:199], a[100:103], v[60:63]
    v_mfma_f32_16x16x32_bf16 v[60:63], a[212:215], a[108:111], v[60:63]
    v_mfma_f32_16x16x32_bf16 v[64:67], a[184:187], a[88:91], v[64:67]
    s_nop 1
    v_mfma_f32_16x16x32_bf16 v[64:67], a[200:203], a[96:99], v[64:67]
    s_nop 1
    v_mfma_f32_16x16x32_bf16 v[64:67], a[216:219], a[104:107], v[64:67]
    ds_write_b128 v9, v[56:59] offset:34816
    s_nop 0
    v_mfma_f32_16x16x32_bf16 v[68:71], a[184:187], a[92:95], v[68:71]
    ds_write_b128 v9, v[60:63] offset:35840
    v_mfma_f32_16x16x32_bf16 v[68:71], a[200:203], a[100:103], v[68:71]
    v_mfma_f32_16x16x32_bf16 v[68:71], a[216:219], a[108:111], v[68:71]
    v_mfma_f32_16x16x32_bf16 v[72:75], a[188:191], a[88:91], v[72:75]
    s_nop 1
    v_mfma_f32_16x16x32_bf16 v[72:75], a[204:207], a[96:99], v[72:75]
    s_nop 1
    v_mfma_f32_16x16x32_bf16 v[72:75], a[220:223], a[104:107], v[72:75]
    ds_write_b128 v11, v[64:67] offset:36864
    s_nop 0
    v_mfma_f32_16x16x32_bf16 v[76:79], a[188:191], a[92:95], v[76:79]
    ds_write_b128 v11, v[68:71] offset:37888
    v_mfma_f32_16x16x32_bf16 v[76:79], a[204:207], a[100:103], v[76:79]
    v_mfma_f32_16x16x32_bf16 v[76:79], a[220:223], a[108:111], v[76:79]
M_TAIL:
    v_cmp_u_f32 vcc, v48, v52
    s_nop 0
    s_cbranch_vccnz SLOWN1
BACKN1:
    s_waitcnt lgkmcnt(0)
    s_barrier
    ds_read_b128 v[16:19], v10 offset:34816
    ds_read_b128 v[20:23], v10 offset:35840
    ds_read_b128 v[24:27], v10 offset:36864
    ds_read_b128 v[28:31], v10 offset:37888
    ds_read_b128 v[32:35], v10 offset:38912
    ds_read_b128 v[36:39], v10 offset:39936
    v_pk_fma_f32 v[200:201], v[160:161], v[72:73], v[200:201]
    v_pk_fma_f32 v[202:203], v[162:163], v[74:75], v[202:203]
    v_pk_fma_f32 v[204:205], v[160:161], v[76:77], v[204:205]
    v_pk_fma_f32 v[206:207], v[162:163], v[78:79], v[206:207]
    s_waitcnt lgkmcnt(3)
    v_pk_add_f32 v[16:17], v[16:17], v[24:25]
    v_pk_add_f32 v[18:19], v[18:19], v[26:27]
    s_waitcnt lgkmcnt(2)
    v_pk_add_f32 v[20:21], v[20:21], v[28:29]
    v_pk_add_f32 v[22:23], v[22:23], v[30:31]
    s_waitcnt lgkmcnt(1)
    v_pk_add_f32 v[16:17], v[16:17], v[32:33]
    v_pk_add_f32 v[18:19], v[18:19], v[34:35]
    s_waitcnt lgkmcnt(0)
    v_pk_add_f32 v[20:21], v[20:21], v[36:37]
    v_pk_add_f32 v[22:23], v[22:23], v[38:39]
    v_pk_fma_f32 v[200:201], v[160:161], v[16:17], v[200:201]
    v_pk_fma_f32 v[202:203], v[162:163], v[18:19], v[202:203]
    v_pk_fma_f32 v[204:205], v[160:161], v[20:21], v[204:205]
    v_pk_fma_f32 v[206:207], v[162:163], v[22:23], v[206:207]
    v_cvt_pk_bf16_f32 v172, v200, v201
    v_cvt_pk_bf16_f32 v174, v204, v205
    v_cvt_pk_bf16_f32 v173, v202, v203
    v_cvt_pk_bf16_f32 v175, v206, v207
    v_permlane16_swap_b32 v172, v174
    s_nop 0
    v_permlane16_swap_b32 v173, v175
    buffer_store_dwordx4 v[172:175], v8, s[20:23], s7 offen
    s_endpgm
K_HELP:
    s_add_u32 s2, s2, 28
    s_and_b32 s2, s2, 31
    s_load_dwordx4 s[44:47], s[0:1], 64
    s_cmp_lt_u32 s2, 14
    s_waitcnt lgkmcnt(0)
    s_cselect_b32 s48, s12, s16
    s_cselect_b32 s49, s13, s17
    s_mov_b64 s[20:21], s[44:45]
    s_mov_b64 s[4:5], s[46:47]
    s_mov_b32 s10, 268435456
    s_mov_b32 s11, 0x00020000
    s_mov_b32 s26, 256
    s_mov_b32 s27, 0x00020000
    s_mov_b32 s58, 2408448
    s_mov_b32 s59, 0x00020000
    s_mov_b32 s6, 896
    s_mov_b32 s7, 0x00020000
    s_mov_b32 s22, 1605632
    s_mov_b32 s23, 0x00020000
    s_mov_b32 s50, 1605632
    s_mov_b32 s51, 0x00020000
    v_lshrrev_b32 v5, 6, v0
    v_and_b32 v1, 63, v0
    v_readfirstlane_b32 s30, v5
    v_lshlrev_b32 v2, 2, v0
    v_and_b32 v5, 3, v1
    s_mul_i32 s3, s30, 224
    v_lshlrev_b32 v72, 2, v1
    buffer_load_dword v3, v72, s[4:7], s3 offen
    v_lshrrev_b32 v6, 3, v1
    v_and_b32 v7, 2, v6
    v_lshlrev_b32 v7, 1, v7
    v_and_b32 v4, 7, v1
    v_xor_b32 v4, v4, v7
    v_lshlrev_b32 v4, 4, v4
    s_mul_i32 s3, s30, 112
    v_add_u32 v6, s3, v6
    v_mul_u32_u24 v6, 5376, v6
    v_add_u32 v4, v4, v6
    s_add_u32 s3, s2, 7
    s_cmp_lt_u32 s2, 21
    s_cselect_b32 s29, s2, s3
    s_sub_u32 s3, 52, s2
    s_cmp_lt_u32 s2, 28
    s_cselect_b32 s29, s29, s3
    s_mov_b32 s43, 1
    s_mul_i32 s44, s30, 14336
    s_add_u32 s44, s44, 4096
    s_lshl_b32 s34, s29, 7
    s_add_u32 m0, s44, 0
    s_nop 0
    buffer_load_dwordx4 v4, s[56:59], s34 offen lds
    s_add_u32 s34, s34, 43008
    s_add_u32 m0, s44, 1024
    s_nop 0
    buffer_load_dwordx4 v4, s[56:59], s34 offen lds
    s_add_u32 s34, s34, 43008
    s_add_u32 m0, s44, 2048
    s_nop 0
    buffer_load_dwordx4 v4, s[56:59], s34 offen lds
    s_add_u32 s34, s34, 43008
    s_add_u32 m0, s44, 3072
    s_nop 0
    buffer_load_dwordx4 v4, s[56:59], s34 offen lds
    s_add_u32 s34, s34, 43008
    s_add_u32 m0, s44, 4096
    s_nop 0
    buffer_load_dwordx4 v4, s[56:59], s34 offen lds
    s_add_u32 s34, s34, 43008
    s_add_u32 m0, s44, 5120
    s_nop 0
    buffer_load_dwordx4 v4, s[56:59], s34 offen lds
    s_add_u32 s34, s34, 43008
    s_add_u32 m0, s44, 6144
    s_nop 0
    buffer_load_dwordx4 v4, s[56:59], s34 offen lds
    s_add_u32 s34, s34, 43008
    s_add_u32 m0, s44, 7168
    s_nop 0
    buffer_load_dwordx4 v4, s[56:59], s34 offen lds
    s_add_u32 s34, s34, 43008
    s_add_u32 m0, s44, 8192
    s_nop 0
    buffer_load_dwordx4 v4, s[56:59], s34 offen lds
    s_add_u32 s34, s34, 43008
    s_add_u32 m0, s44, 9216
    s_nop 0
    buffer_load_dwordx4 v4, s[56:59], s34 offen lds
    s_add_u32 s34, s34, 43008
    s_add_u32 m0, s44, 10240
    s_nop 0
    buffer_load_dwordx4 v4, s[56:59], s34 offen lds
    s_add_u32 s34, s34, 43008
    s_lshl_b32 s35, s30, 10
    v_cmp_eq_u32 vcc, 0, v0
    v_mov_b32 v14, 0x7ffffffc
    v_lshlrev_b32 v15, 2, v5
    v_cndmask_b32 v12, v14, 0, vcc
    s_mul_i32 s38, s2, 128
    s_add_u32 s38, s38, 2555904
    v_and_b32 v6, 0xf9, v0
    v_bfe_u32 v7, v0, 1, 1
    v_lshl_add_u32 v6, v7, 2, v6
    v_bfe_u32 v7, v0, 2, 1
    v_lshl_add_u32 v6, v7, 1, v6
    v_lshlrev_b32 v6, 2, v6
    v_lshrrev_b32 v8, 5, v1
    v_bfe_u32 v9, v1, 2, 2
    v_lshl_add_u32 v7, v8, 2, v9
    v_lshlrev_b32 v13, 7, v7
    v_lshrrev_b32 v9, 1, v9
    v_lshl_add_u32 v13, v9, 6, v13
    v_bfe_u32 v9, v1, 4, 1
    v_lshl_add_u32 v13, v9, 5, v13
    v_lshl_add_u32 v13, v5, 3, v13
    v_xor_b32 v73, 64, v13
    v_add_u32 v13, s44, v13
    v_add_u32 v73, s44, v73
    s_lshl_b32 s3, s30, 8
    v_lshl_add_u32 v74, v8, 4, s3
    v_and_b32 v71, 1, v1
    v_lshlrev_b32 v71, 5, v71
    v_and_b32 v9, 4, v1
    v_add_u32 v71, v71, v9
    v_bfe_u32 v9, v1, 1, 1
    v_add_u32 v71, v71, v9
    v_bfe_u32 v9, v1, 3, 1
    v_lshl_add_u32 v71, v9, 1, v71
    v_bfe_u32 v9, v1, 4, 2
    v_lshl_add_u32 v71, v9, 3, v71
    v_lshlrev_b32 v71, 2, v71
    v_add_u32 v71, 40960, v71
    s_waitcnt vmcnt(11)
    v_lshlrev_b32 v7, 16, v3
    v_and_b32 v3, 0xffff0000, v3
    v_mul_f32 v9, 0xbfb8aa3b, v7
    v_mul_f32 v10, 0xbfb8aa3b, v3
    v_exp_f32 v9, v9
    v_exp_f32 v10, v10
    v_add_f32 v9, 1.0, v9
    v_add_f32 v10, 1.0, v10
    v_rcp_f32 v9, v9
    v_rcp_f32 v10, v10
    v_mul_f32 v7, v7, v9
    v_mul_f32 v3, v3, v10
    v_cvt_pk_bf16_f32 v7, v7, v3
    ds_write_b32 v6, v7
    ds_read_b128 v[16:19], v74
    ds_read_b128 v[20:23], v74 offset:32
    ds_read_b128 v[24:27], v74 offset:64
    ds_read_b128 v[28:31], v74 offset:96
    ds_read_b128 v[32:35], v74 offset:128
    ds_read_b128 v[36:39], v74 offset:160
    ds_read_b128 v[40:43], v74 offset:192
    s_waitcnt lgkmcnt(0)
    s_add_u32 m0, s44, 11264
    s_nop 0
    buffer_load_dwordx4 v4, s[56:59], s34 offen lds
    s_add_u32 s34, s34, 43008
    s_add_u32 m0, s44, 12288
    s_nop 0
    buffer_load_dwordx4 v4, s[56:59], s34 offen lds
    s_add_u32 s34, s34, 43008
    s_add_u32 m0, s44, 13312
    s_nop 0
    buffer_load_dwordx4 v4, s[56:59], s34 offen lds
    s_add_u32 s34, s34, 43008
    v_lshlrev_b32 v75, 4, v1
    s_mul_i32 s37, s30, 14336
    s_mul_i32 s46, s2, 57344
    s_add_u32 s46, s46, s37
    s_add_u32 s37, s37, 106496
    s_cmp_lt_u32 s2, 28
    s_cbranch_scc1 H_LAST
    buffer_load_dword v11, v15, s[24:27], 0 offen sc1
H_LOOP:
    s_add_u32 s45, s29, 4
    s_cmp_eq_u32 s2, 28
    s_cselect_b32 s45, s29, s45
    s_lshl_b32 s34, s45, 7
    s_xor_b32 s44, s44, 0x10000
    s_add_u32 m0, s44, 0
    s_nop 0
    buffer_load_dwordx4 v4, s[56:59], s34 offen lds
    s_add_u32 s34, s34, 43008
    s_add_u32 m0, s44, 1024
    s_nop 0
    buffer_load_dwordx4 v4, s[56:59], s34 offen lds
    s_add_u32 s34, s34, 43008
    s_add_u32 m0, s44, 2048
    s_nop 0
    buffer_load_dwordx4 v4, s[56:59], s34 offen lds
    s_add_u32 s34, s34, 43008
    s_add_u32 m0, s44, 3072
    s_nop 0
    buffer_load_dwordx4 v4, s[56:59], s34 offen lds
    s_add_u32 s34, s34, 43008
    s_add_u32 m0, s44, 4096
    s_nop 0
    buffer_load_dwordx4 v4, s[56:59], s34 offen lds
    s_add_u32 s34, s34, 43008
    s_add_u32 m0, s44, 5120
    s_nop 0
    buffer_load_dwordx4 v4, s[56:59], s34 offen lds
    s_add_u32 s34, s34, 43008
    s_add_u32 m0, s44, 6144
    s_nop 0
    buffer_load_dwordx4 v4, s[56:59], s34 offen lds
    s_add_u32 s34, s34, 43008
    s_add_u32 m0, s44, 7168
    s_nop 0
    buffer_load_dwordx4 v4, s[56:59], s34 offen lds
    s_add_u32 s34, s34, 43008
    s_add_u32 m0, s44, 8192
    s_nop 0
    buffer_load_dwordx4 v4, s[56:59], s34 offen lds
    s_add_u32 s34, s34, 43008
    s_add_u32 m0, s44, 9216
    s_nop 0
    buffer_load_dwordx4 v4, s[56:59], s34 offen lds
    s_add_u32 s34, s34, 43008
    s_add_u32 m0, s44, 10240
    s_nop 0
    buffer_load_dwordx4 v4, s[56:59], s34 offen lds
    s_add_u32 s34, s34, 43008
    s_add_u32 m0, s44, 11264
    s_nop 0
    buffer_load_dwordx4 v4, s[56:59], s34 offen lds
    s_add_u32 s34, s34, 43008
    s_add_u32 m0, s44, 12288
    s_nop 0
    buffer_load_dwordx4 v4, s[56:59], s34 offen lds
    s_add_u32 s34, s34, 43008
    s_add_u32 m0, s44, 13312
    s_nop 0
    buffer_load_dwordx4 v4, s[56:59], s34 offen lds
    s_add_u32 s34, s34, 43008
    s_waitcnt vmcnt(14)
    s_waitcnt vmcnt(26)
    ds_read_b64_tr_b16 v[128:129], v13
    ds_read_b64_tr_b16 v[130:131], v13 offset:1024
    ds_read_b64_tr_b16 v[132:133], v73
    ds_read_b64_tr_b16 v[134:135], v73 offset:1024
    s_waitcnt vmcnt(24)
    ds_read_b64_tr_b16 v[136:137], v13 offset:2048
    ds_read_b64_tr_b16 v[138:139], v13 offset:3072
    ds_read_b64_tr_b16 v[140:141], v73 offset:2048
    ds_read_b64_tr_b16 v[142:143], v73 offset:3072
    s_waitcnt lgkmcnt(6)
    v_mfma_f32_32x32x16_bf16 v[224:239], v[16:19], v[128:131], 0
    s_waitcnt lgkmcnt(4)
    v_mfma_f32_32x32x16_bf16 v[240:255], v[16:19], v[132:135], 0
    s_waitcnt vmcnt(22)
    ds_read_b64_tr_b16 v[144:145], v13 offset:4096
    ds_read_b64_tr_b16 v[146:147], v13 offset:5120
    ds_read_b64_tr_b16 v[148:149], v73 offset:4096
    ds_read_b64_tr_b16 v[150:151], v73 offset:5120
    s_waitcnt lgkmcnt(6)
    v_mfma_f32_32x32x16_bf16 v[224:239], v[20:23], v[136:139], v[224:239]
    s_waitcnt lgkmcnt(4)
    v_mfma_f32_32x32x16_bf16 v[240:255], v[20:23], v[140:143], v[240:255]
    s_waitcnt vmcnt(20)
    ds_read_b64_tr_b16 v[152:153], v13 offset:6144
    ds_read_b64_tr_b16 v[154:155], v13 offset:7168
    ds_read_b64_tr_b16 v[156:157], v73 offset:6144
    ds_read_b64_tr_b16 v[158:159], v73 offset:7168
    s_waitcnt lgkmcnt(6)
    v_mfma_f32_32x32x16_bf16 v[224:239], v[24:27], v[144:147], v[224:239]
    s_waitcnt lgkmcnt(4)
    v_mfma_f32_32x32x16_bf16 v[240:255], v[24:27], v[148:151], v[240:255]
    s_waitcnt vmcnt(18)
    ds_read_b64_tr_b16 v[160:161], v13 offset:8192
    ds_read_b64_tr_b16 v[162:163], v13 offset:9216
    ds_read_b64_tr_b16 v[164:165], v73 offset:8192
    ds_read_b64_tr_b16 v[166:167], v73 offset:9216
    s_waitcnt lgkmcnt(6)
    v_mfma_f32_32x32x16_bf16 v[224:239], v[28:31], v[152:155], v[224:239]
    s_waitcnt lgkmcnt(4)
    v_mfma_f32_32x32x16_bf16 v[240:255], v[28:31], v[156:159], v[240:255]
    s_waitcnt vmcnt(16)
    ds_read_b64_tr_b16 v[168:169], v13 offset:10240
    ds_read_b64_tr_b16 v[170:171], v13 offset:11264
    ds_read_b64_tr_b16 v[172:173], v73 offset:10240
    ds_read_b64_tr_b16 v[174:175], v73 offset:11264
    s_waitcnt lgkmcnt(6)
    v_mfma_f32_32x32x16_bf16 v[224:239], v[32:35], v[160:163], v[224:239]
    s_waitcnt lgkmcnt(4)
    v_mfma_f32_32x32x16_bf16 v[240:255], v[32:35], v[164:167], v[240:255]
    s_waitcnt vmcnt(14)
    ds_read_b64_tr_b16 v[176:177], v13 offset:12288
    ds_read_b64_tr_b16 v[178:179], v13 offset:13312
    ds_read_b64_tr_b16 v[180:181], v73 offset:12288
    ds_read_b64_tr_b16 v[182:183], v73 offset:13312
    s_waitcnt lgkmcnt(6)
    v_mfma_f32_32x32x16_bf16 v[224:239], v[36:39], v[168:171], v[224:239]
    s_waitcnt lgkmcnt(4)
    v_mfma_f32_32x32x16_bf16 v[240:255], v[36:39], v[172:175], v[240:255]
    s_waitcnt lgkmcnt(2)
    v_mfma_f32_32x32x16_bf16 v[224:239], v[40:43], v[176:179], v[224:239]
    s_waitcnt lgkmcnt(0)
    v_mfma_f32_32x32x16_bf16 v[240:255], v[40:43], v[180:183], v[240:255]
    s_branch H_RED
H_LAST:
    s_waitcnt vmcnt(12)
    ds_read_b64_tr_b16 v[128:129], v13
    ds_read_b64_tr_b16 v[130:131], v13 offset:1024
    ds_read_b64_tr_b16 v[132:133], v73
    ds_read_b64_tr_b16 v[134:135], v73 offset:1024
    s_waitcnt vmcnt(10)
    ds_read_b64_tr_b16 v[136:137], v13 offset:2048
    ds_read_b64_tr_b16 v[138:139], v13 offset:3072
    ds_read_b64_tr_b16 v[140:141], v73 offset:2048
    ds_read_b64_tr_b16 v[142:143], v73 offset:3072
    s_waitcnt lgkmcnt(6)
    v_mfma_f32_32x32x16_bf16 v[224:239], v[16:19], v[128:131], 0
    s_waitcnt lgkmcnt(4)
    v_mfma_f32_32x32x16_bf16 v[240:255], v[16:19], v[132:135], 0
    s_waitcnt vmcnt(8)
    ds_read_b64_tr_b16 v[144:145], v13 offset:4096
    ds_read_b64_tr_b16 v[146:147], v13 offset:5120
    ds_read_b64_tr_b16 v[148:149], v73 offset:4096
    ds_read_b64_tr_b16 v[150:151], v73 offset:5120
    s_waitcnt lgkmcnt(6)
    v_mfma_f32_32x32x16_bf16 v[224:239], v[20:23], v[136:139], v[224:239]
    s_waitcnt lgkmcnt(4)
    v_mfma_f32_32x32x16_bf16 v[240:255], v[20:23], v[140:143], v[240:255]
    s_waitcnt vmcnt(6)
    ds_read_b64_tr_b16 v[152:153], v13 offset:6144
    ds_read_b64_tr_b16 v[154:155], v13 offset:7168
    ds_read_b64_tr_b16 v[156:157], v73 offset:6144
    ds_read_b64_tr_b16 v[158:159], v73 offset:7168
    s_waitcnt lgkmcnt(6)
    v_mfma_f32_32x32x16_bf16 v[224:239], v[24:27], v[144:147], v[224:239]
    s_waitcnt lgkmcnt(4)
    v_mfma_f32_32x32x16_bf16 v[240:255], v[24:27], v[148:151], v[240:255]
    s_waitcnt vmcnt(4)
    buffer_load_dword v11, v15, s[24:27], 0 offen sc1
    ds_read_b64_tr_b16 v[160:161], v13 offset:8192
    ds_read_b64_tr_b16 v[162:163], v13 offset:9216
    ds_read_b64_tr_b16 v[164:165], v73 offset:8192
    ds_read_b64_tr_b16 v[166:167], v73 offset:9216
    s_waitcnt lgkmcnt(6)
    v_mfma_f32_32x32x16_bf16 v[224:239], v[28:31], v[152:155], v[224:239]
    s_waitcnt lgkmcnt(4)
    v_mfma_f32_32x32x16_bf16 v[240:255], v[28:31], v[156:159], v[240:255]
    s_waitcnt vmcnt(3)
    ds_read_b64_tr_b16 v[168:169], v13 offset:10240
    ds_read_b64_tr_b16 v[170:171], v13 offset:11264
    ds_read_b64_tr_b16 v[172:173], v73 offset:10240
    ds_read_b64_tr_b16 v[174:175], v73 offset:11264
    s_waitcnt lgkmcnt(6)
    v_mfma_f32_32x32x16_bf16 v[224:239], v[32:35], v[160:163], v[224:239]
    s_waitcnt lgkmcnt(4)
    v_mfma_f32_32x32x16_bf16 v[240:255], v[32:35], v[164:167], v[240:255]
    s_waitcnt vmcnt(1)
    ds_read_b64_tr_b16 v[176:177], v13 offset:12288
    ds_read_b64_tr_b16 v[178:179], v13 offset:13312
    ds_read_b64_tr_b16 v[180:181], v73 offset:12288
    ds_read_b64_tr_b16 v[182:183], v73 offset:13312
    s_waitcnt lgkmcnt(6)
    v_mfma_f32_32x32x16_bf16 v[224:239], v[36:39], v[168:171], v[224:239]
    s_waitcnt lgkmcnt(4)
    v_mfma_f32_32x32x16_bf16 v[240:255], v[36:39], v[172:175], v[240:255]
    s_waitcnt lgkmcnt(2)
    v_mfma_f32_32x32x16_bf16 v[224:239], v[40:43], v[176:179], v[224:239]
    s_waitcnt lgkmcnt(0)
    v_mfma_f32_32x32x16_bf16 v[240:255], v[40:43], v[180:183], v[240:255]
    s_waitcnt vmcnt(0)
    s_cmp_ge_u32 s2, 28
    s_cbranch_scc1 H_RED
H_RED:
    s_mul_i32 s3, s29, 37
    s_lshr_b32 s3, s3, 8
    s_lshr_b32 s3, 0x12, s3
    s_and_b32 s3, s3, 1
    s_mul_i32 s40, s3, 0x3f800000
    s_lshl_b32 s39, s29, 8
    s_add_u32 s39, s39, 2539520
    v_cmp_gt_u32 vcc, 32, v1
    s_nop 2
    v_cndmask_b32 v76, v240, v224, vcc
    ds_write_b32 v2, v76 offset:2048
    s_waitcnt lgkmcnt(0)
    s_barrier
    s_cmp_lg_u32 s30, 0
    s_cbranch_scc1 H_J1D
    ds_read_b32 v76, v72 offset:2048
    ds_read_b32 v77, v72 offset:2304
    ds_read_b32 v78, v72 offset:2560
    ds_read_b32 v79, v72 offset:2816
    v_cmp_gt_u32 vcc, 1, v11
    s_nop 0
    s_cbranch_vccz H_RDY
    s_mov_b32 s55, 0
POLL10:
    buffer_load_dword v11, v15, s[24:27], 0 offen sc1
    s_add_u32 s55, s55, 1
    s_waitcnt vmcnt(0)
    v_cmp_gt_u32 vcc, 1, v11
    s_nop 0
    s_cbranch_vccz POLL10D
    s_cmp_lt_u32 s55, 20000
    s_cbranch_scc1 POLL10
POLL10D:
H_RDY:
    s_waitcnt lgkmcnt(2)
    v_add_f32 v76, v76, v77
    s_waitcnt lgkmcnt(0)
    v_add_f32 v78, v78, v79
    v_add_f32 v76, v76, v78
    v_cvt_pk_bf16_f32 v76, v76, v76
    v_and_b32 v76, 0xffff0000, v76
    v_add_f32 v76, s40, v76
    v_cvt_pk_bf16_f32 v76, v76, v76
    v_and_b32 v76, 0xffff0000, v76
    v_or_b32 v76, 1, v76
    s_cmp_ge_u32 s29, 14
    s_cbranch_scc1 H_NOR
    s_cmp_ge_u32 s29, 7
    s_cselect_b32 s3, 1792, 0
    s_add_u32 s3, s3, s39
    buffer_store_dword v76, v71, s[8:11], s3 offen sc1
    buffer_store_dword v76, v71, s[8:11], s3 offen offset:1792 sc1
H_NOR:
    buffer_store_dword v76, v72, s[8:11], s39 offen sc1
H_J1D:
    s_barrier
    s_cmp_lt_u32 s2, 28
    s_cbranch_scc1 H_NEXT
    s_cmp_eq_u32 s43, 4
    s_cbranch_scc1 K_END
    s_add_u32 s43, s43, 1
    s_mov_b32 s29, s45
    v_xor_b32 v13, 0x10000, v13
    v_xor_b32 v73, 0x10000, v73
    s_cmp_lg_u32 s43, 3
    s_waitcnt vmcnt(0)
    s_cbranch_scc1 H_LAST
    v_mov_b32 v64, -1
    v_mov_b32 v65, -1
    v_mov_b32 v66, -1
    v_mov_b32 v67, -1
    s_cmp_lt_u32 s2, 30
    s_cselect_b32 s46, 0, 3670016
    s_mul_i32 s3, s30, 28672
    s_add_u32 s46, s46, s3
    s_add_u32 s46, s46, 9568256
    s_bitcmp1_b32 s2, 0
    s_cselect_b32 s3, 14336, 0
    s_cselect_b32 s47, 0, 114688
    s_add_u32 s46, s46, s3
    s_add_u32 s3, s46, s47
    s_mov_b32 s47, 0
H_SPZ:
    buffer_store_dwordx4 v[64:67], v75, s[8:11], s3 offen sc1
    buffer_store_dwordx4 v[64:67], v75, s[8:11], s3 offen offset:1024 sc1
    buffer_store_dwordx4 v[64:67], v75, s[8:11], s3 offen offset:2048 sc1
    buffer_store_dwordx4 v[64:67], v75, s[8:11], s3 offen offset:3072 sc1
    s_add_u32 s3, s3, 4096
    buffer_store_dwordx4 v[64:67], v75, s[8:11], s3 offen sc1
    buffer_store_dwordx4 v[64:67], v75, s[8:11], s3 offen offset:1024 sc1
    buffer_store_dwordx4 v[64:67], v75, s[8:11], s3 offen offset:2048 sc1
    buffer_store_dwordx4 v[64:67], v75, s[8:11], s3 offen offset:3072 sc1
    s_add_u32 s3, s3, 4096
    buffer_store_dwordx4 v[64:67], v75, s[8:11], s3 offen sc1
    buffer_store_dwordx4 v[64:67], v75, s[8:11], s3 offen offset:1024 sc1
    buffer_store_dwordx4 v[64:67], v75, s[8:11], s3 offen offset:2048 sc1
    buffer_store_dwordx4 v[64:67], v75, s[8:11], s3 offen offset:3072 sc1
    s_add_u32 s3, s3, 4096
    buffer_store_dwordx4 v[64:67], v75, s[8:11], s3 offen sc1
    buffer_store_dwordx4 v[64:67], v75, s[8:11], s3 offen offset:1024 sc1
    s_add_u32 s47, s47, 1
    s_mul_i32 s3, s47, 114688
    s_add_u32 s3, s3, 114688
    s_add_u32 s3, s3, s46
    s_cmp_lt_u32 s47, 3
    s_cbranch_scc1 H_SPZ
    s_lshl_b32 s3, s2, 2
    s_add_u32 s3, s3, s30
    s_lshl_b32 s3, s3, 6
    s_add_u32 s3, s3, 2560000
    v_min_u32 v12, 1, v1
    v_lshlrev_b32 v12, 30, v12
    v_mov_b32 v14, 1
    s_waitcnt vmcnt(0)
    buffer_store_dword v14, v12, s[8:11], s3 offen sc1
    s_sub_u32 s29, 66, s2
    s_lshl_b32 s34, s29, 7
    s_xor_b32 s44, s44, 0x10000
    s_add_u32 m0, s44, 0
    s_nop 0
    buffer_load_dwordx4 v4, s[56:59], s34 offen lds
    s_add_u32 s34, s34, 43008
    s_add_u32 m0, s44, 1024
    s_nop 0
    buffer_load_dwordx4 v4, s[56:59], s34 offen lds
    s_add_u32 s34, s34, 43008
    s_add_u32 m0, s44, 2048
    s_nop 0
    buffer_load_dwordx4 v4, s[56:59], s34 offen lds
    s_add_u32 s34, s34, 43008
    s_add_u32 m0, s44, 3072
    s_nop 0
    buffer_load_dwordx4 v4, s[56:59], s34 offen lds
    s_add_u32 s34, s34, 43008
    s_add_u32 m0, s44, 4096
    s_nop 0
    buffer_load_dwordx4 v4, s[56:59], s34 offen lds
    s_add_u32 s34, s34, 43008
    s_add_u32 m0, s44, 5120
    s_nop 0
    buffer_load_dwordx4 v4, s[56:59], s34 offen lds
    s_add_u32 s34, s34, 43008
    s_add_u32 m0, s44, 6144
    s_nop 0
    buffer_load_dwordx4 v4, s[56:59], s34 offen lds
    s_add_u32 s34, s34, 43008
    s_add_u32 m0, s44, 7168
    s_nop 0
    buffer_load_dwordx4 v4, s[56:59], s34 offen lds
    s_add_u32 s34, s34, 43008
    s_add_u32 m0, s44, 8192
    s_nop 0
    buffer_load_dwordx4 v4, s[56:59], s34 offen lds
    s_add_u32 s34, s34, 43008
    s_add_u32 m0, s44, 9216
    s_nop 0
    buffer_load_dwordx4 v4, s[56:59], s34 offen lds
    s_add_u32 s34, s34, 43008
    s_add_u32 m0, s44, 10240
    s_nop 0
    buffer_load_dwordx4 v4, s[56:59], s34 offen lds
    s_add_u32 s34, s34, 43008
    s_add_u32 m0, s44, 11264
    s_nop 0
    buffer_load_dwordx4 v4, s[56:59], s34 offen lds
    s_add_u32 s34, s34, 43008
    s_add_u32 m0, s44, 12288
    s_nop 0
    buffer_load_dwordx4 v4, s[56:59], s34 offen lds
    s_add_u32 s34, s34, 43008
    s_add_u32 m0, s44, 13312
    s_nop 0
    buffer_load_dwordx4 v4, s[56:59], s34 offen lds
    s_add_u32 s34, s34, 43008
    s_branch H_LOOP
H_NEXT:
    s_add_u32 m0, s37, 0
    s_add_u32 s36, s46, 0
    buffer_load_dwordx4 v75, s[20:23], s36 offen lds
    s_add_u32 m0, s37, 1024
    s_add_u32 s36, s46, 1024
    buffer_load_dwordx4 v75, s[20:23], s36 offen lds
    s_add_u32 m0, s37, 2048
    s_add_u32 s36, s46, 2048
    buffer_load_dwordx4 v75, s[20:23], s36 offen lds
    s_add_u32 m0, s37, 3072
    s_add_u32 s36, s46, 3072
    buffer_load_dwordx4 v75, s[20:23], s36 offen lds
    s_add_u32 m0, s37, 4096
    s_add_u32 s36, s46, 4096
    buffer_load_dwordx4 v75, s[20:23], s36 offen lds
    s_add_u32 m0, s37, 5120
    s_add_u32 s36, s46, 5120
    buffer_load_dwordx4 v75, s[20:23], s36 offen lds
    s_add_u32 m0, s37, 6144
    s_add_u32 s36, s46, 6144
    buffer_load_dwordx4 v75, s[20:23], s36 offen lds
    s_add_u32 m0, s37, 7168
    s_add_u32 s36, s46, 7168
    buffer_load_dwordx4 v75, s[20:23], s36 offen lds
    s_add_u32 m0, s37, 8192
    s_add_u32 s36, s46, 8192
    buffer_load_dwordx4 v75, s[20:23], s36 offen lds
    s_add_u32 m0, s37, 9216
    s_add_u32 s36, s46, 9216
    buffer_load_dwordx4 v75, s[20:23], s36 offen lds
    s_add_u32 m0, s37, 10240
    s_add_u32 s36, s46, 10240
    buffer_load_dwordx4 v75, s[20:23], s36 offen lds
    s_add_u32 m0, s37, 11264
    s_add_u32 s36, s46, 11264
    buffer_load_dwordx4 v75, s[20:23], s36 offen lds
    s_add_u32 m0, s37, 12288
    s_add_u32 s36, s46, 12288
    buffer_load_dwordx4 v75, s[20:23], s36 offen lds
    s_add_u32 m0, s37, 13312
    s_add_u32 s36, s46, 13312
    buffer_load_dwordx4 v75, s[20:23], s36 offen lds
    v_lshlrev_b32 v78, 2, v8
    v_bfe_u32 v10, v1, 2, 2
    v_add_u32 v78, v78, v10
    v_mul_u32_u24 v78, 896, v78
    v_bfe_u32 v10, v1, 4, 1
    v_lshl_add_u32 v78, v10, 5, v78
    v_lshl_add_u32 v78, v5, 3, v78
    v_add_u32 v78, s37, v78
    s_and_b32 s3, s2, 1
    s_lshl_b32 s3, s3, 1
    s_lshr_b32 s36, s30, 1
    s_add_u32 s3, s3, s36
    s_mul_i32 s34, s3, 57344
    s_lshr_b32 s3, s2, 1
    s_lshl_b32 s3, s3, 12
    s_add_u32 s34, s34, s3
    s_and_b32 s3, s30, 1
    s_lshl_b32 s3, s3, 9
    s_add_u32 s34, s34, s3
    s_add_u32 s34, s34, 4718592
    v_lshrrev_b32 v6, 4, v1
    v_lshlrev_b32 v7, 2, v6
    v_and_b32 v4, 15, v1
    v_xor_b32 v4, v4, v7
    v_lshlrev_b32 v4, 4, v4
    v_lshl_add_u32 v6, s30, 2, v6
    v_mul_u32_u24 v6, 3584, v6
    v_add_u32 v4, v4, v6
    s_sub_u32 s3, s2, 14
    s_cmp_lt_u32 s2, 14
    s_cselect_b32 s41, s2, s3
    s_cselect_b32 s42, 0, 28672
    s_and_b32 s3, s41, 1
    s_mul_i32 s3, s3, 7
    s_lshr_b32 s41, s41, 1
    s_add_u32 s41, s41, s3
    s_lshl_b32 s3, s41, 11
    s_add_u32 s42, s42, s3
    s_lshl_b32 s41, s41, 8
    v_mov_b32 v64, -1
    v_mov_b32 v65, -1
    v_mov_b32 v66, -1
    v_mov_b32 v67, -1
    s_cmp_lt_u32 s2, 14
    s_cselect_b32 s45, 0, 3670016
    s_lshl_b32 s3, s41, 3
    s_add_u32 s45, s45, s3
    s_mul_i32 s3, s30, 28672
    s_add_u32 s45, s45, s3
    s_add_u32 s45, s45, 6356992
    s_bitcmp1_b32 s2, 0
    s_cselect_b32 s3, 0, 114688
    s_add_u32 s45, s45, s3
    s_sub_u32 s46, 229376, s3
    s_add_u32 s47, s3, 114688
    v_lshl_add_u32 v63, v8, 30, v75
    s_lshl_b32 s36, s30, 9
    s_add_u32 s42, s42, s36
    s_add_u32 s42, s42, 1835008
    buffer_store_dwordx4 v[64:67], v63, s[8:11], s42 offen sc1
    s_add_u32 m0, s35, 4096
    s_nop 0
    buffer_load_dwordx4 v4, s[48:51], s41 offen lds
    s_add_u32 s41, s41, 57344
    s_add_u32 m0, s35, 8192
    s_nop 0
    buffer_load_dwordx4 v4, s[48:51], s41 offen lds
    s_add_u32 s41, s41, 57344
    s_add_u32 m0, s35, 12288
    s_nop 0
    buffer_load_dwordx4 v4, s[48:51], s41 offen lds
    s_add_u32 s41, s41, 57344
    s_add_u32 m0, s35, 16384
    s_nop 0
    buffer_load_dwordx4 v4, s[48:51], s41 offen lds
    s_add_u32 s41, s41, 57344
    s_add_u32 m0, s35, 20480
    s_nop 0
    buffer_load_dwordx4 v4, s[48:51], s41 offen lds
    s_add_u32 s41, s41, 57344
    s_add_u32 m0, s35, 24576
    s_nop 0
    buffer_load_dwordx4 v4, s[48:51], s41 offen lds
    s_add_u32 s41, s41, 57344
    s_add_u32 m0, s35, 28672
    s_nop 0
    buffer_load_dwordx4 v4, s[48:51], s41 offen lds
    s_add_u32 s41, s41, 57344
    s_add_u32 m0, s35, 32768
    s_nop 0
    buffer_load_dwordx4 v4, s[48:51], s41 offen lds
    s_add_u32 s41, s41, 57344
    s_waitcnt vmcnt(9)
    ds_read_b64_tr_b16 v[184:185], v78
    ds_read_b64_tr_b16 v[186:187], v78 offset:7168
    ds_read_b64_tr_b16 v[188:189], v78 offset:64
    ds_read_b64_tr_b16 v[190:191], v78 offset:7232
    ds_read_b64_tr_b16 v[192:193], v78 offset:128
    ds_read_b64_tr_b16 v[194:195], v78 offset:7296
    ds_read_b64_tr_b16 v[196:197], v78 offset:192
    ds_read_b64_tr_b16 v[198:199], v78 offset:7360
    ds_read_b64_tr_b16 v[200:201], v78 offset:256
    ds_read_b64_tr_b16 v[202:203], v78 offset:7424
    ds_read_b64_tr_b16 v[204:205], v78 offset:320
    ds_read_b64_tr_b16 v[206:207], v78 offset:7488
    ds_read_b64_tr_b16 v[208:209], v78 offset:384
    ds_read_b64_tr_b16 v[210:211], v78 offset:7552
    ds_read_b64_tr_b16 v[212:213], v78 offset:448
    ds_read_b64_tr_b16 v[214:215], v78 offset:7616
    ds_read_b64_tr_b16 v[216:217], v78 offset:512
    ds_read_b64_tr_b16 v[218:219], v78 offset:7680
    ds_read_b64_tr_b16 v[220:221], v78 offset:576
    ds_read_b64_tr_b16 v[222:223], v78 offset:7744
    ds_read_b64_tr_b16 v[224:225], v78 offset:640
    ds_read_b64_tr_b16 v[226:227], v78 offset:7808
    ds_read_b64_tr_b16 v[228:229], v78 offset:704
    ds_read_b64_tr_b16 v[230:231], v78 offset:7872
    ds_read_b64_tr_b16 v[232:233], v78 offset:768
    ds_read_b64_tr_b16 v[234:235], v78 offset:7936
    ds_read_b64_tr_b16 v[236:237], v78 offset:832
    ds_read_b64_tr_b16 v[238:239], v78 offset:8000
    s_and_b32 s3, s2, 1
    s_xor_b32 s3, s3, 1
    s_lshl_b32 s3, s3, 10
    s_lshr_b32 s39, s30, 1
    s_xor_b32 s39, s39, 1
    s_lshl_b32 s39, s39, 11
    s_or_b32 s3, s3, s39
    v_and_b32 v69, 15, v1
    v_lshlrev_b32 v69, 4, v69
    v_lshl_add_u32 v69, v8, 8, v69
    v_bfe_u32 v70, v1, 4, 1
    v_lshl_add_u32 v69, v70, 10, v69
    v_xor_b32 v69, s3, v69
    v_xor_b32 v70, 2048, v69
    s_lshr_b32 s39, s2, 1
    s_sub_u32 s3, s39, 7
    s_cmp_ge_u32 s39, 7
    s_cselect_b32 s39, s3, s39
    s_waitcnt lgkmcnt(14)
    buffer_store_dwordx4 v[184:187], v69, s[8:11], s34 offen sc1
    s_waitcnt lgkmcnt(12)
    buffer_store_dwordx4 v[212:215], v70, s[8:11], s34 offen sc1
    s_cmp_eq_u32 s39, 0
    s_cselect_b32 s3, 28672, 0
    s_add_u32 s34, s34, s3
    s_add_u32 s34, s34, 225280
    buffer_store_dwordx4 v[188:191], v69, s[8:11], s34 offen sc1
    s_waitcnt lgkmcnt(10)
    buffer_store_dwordx4 v[216:219], v70, s[8:11], s34 offen sc1
    s_cmp_eq_u32 s39, 1
    s_cselect_b32 s3, 28672, 0
    s_add_u32 s34, s34, s3
    s_add_u32 s34, s34, 225280
    buffer_store_dwordx4 v[192:195], v69, s[8:11], s34 offen sc1
    s_waitcnt lgkmcnt(8)
    buffer_store_dwordx4 v[220:223], v70, s[8:11], s34 offen sc1
    s_cmp_eq_u32 s39, 2
    s_cselect_b32 s3, 28672, 0
    s_add_u32 s34, s34, s3
    s_add_u32 s34, s34, 225280
    buffer_store_dwordx4 v[196:199], v69, s[8:11], s34 offen sc1
    s_waitcnt lgkmcnt(6)
    buffer_store_dwordx4 v[224:227], v70, s[8:11], s34 offen sc1
    s_cmp_eq_u32 s39, 3
    s_cselect_b32 s3, 28672, 0
    s_add_u32 s34, s34, s3
    s_add_u32 s34, s34, 225280
    buffer_store_dwordx4 v[200:203], v69, s[8:11], s34 offen sc1
    s_waitcnt lgkmcnt(4)
    buffer_store_dwordx4 v[228:231], v70, s[8:11], s34 offen sc1
    s_cmp_eq_u32 s39, 4
    s_cselect_b32 s3, 28672, 0
    s_add_u32 s34, s34, s3
    s_add_u32 s34, s34, 225280
    buffer_store_dwordx4 v[204:207], v69, s[8:11], s34 offen sc1
    s_waitcnt lgkmcnt(2)
    buffer_store_dwordx4 v[232:235], v70, s[8:11], s34 offen sc1
    s_cmp_eq_u32 s39, 5
    s_cselect_b32 s3, 28672, 0
    s_add_u32 s34, s34, s3
    s_add_u32 s34, s34, 225280
    buffer_store_dwordx4 v[208:211], v69, s[8:11], s34 offen sc1
    s_waitcnt lgkmcnt(0)
    buffer_store_dwordx4 v[236:239], v70, s[8:11], s34 offen sc1
    s_cmp_eq_u32 s39, 6
    s_cselect_b32 s3, 28672, 0
    s_add_u32 s34, s34, s3
    s_add_u32 s34, s34, 225280
    s_add_u32 m0, s35, 36864
    s_nop 0
    buffer_load_dwordx4 v4, s[48:51], s41 offen lds
    s_add_u32 s41, s41, 57344
    s_add_u32 m0, s35, 40960
    s_nop 0
    buffer_load_dwordx4 v4, s[48:51], s41 offen lds
    s_add_u32 s41, s41, 57344
    s_add_u32 m0, s35, 45056
    s_nop 0
    buffer_load_dwordx4 v4, s[48:51], s41 offen lds
    s_add_u32 s41, s41, 57344
    s_add_u32 m0, s35, 49152
    s_nop 0
    buffer_load_dwordx4 v4, s[48:51], s41 offen lds
    s_add_u32 s41, s41, 57344
    s_add_u32 m0, s35, 53248
    s_nop 0
    buffer_load_dwordx4 v4, s[48:51], s41 offen lds
    s_add_u32 s41, s41, 57344
    s_add_u32 m0, s35, 57344
    s_nop 0
    buffer_load_dwordx4 v4, s[48:51], s41 offen lds
    s_add_u32 s41, s41, 57344
    s_add_u32 m0, s35, 61440
    s_nop 0
    buffer_load_dwordx4 v4, s[48:51], s41 offen lds
    s_add_u32 s41, s41, 57344
    s_add_u32 m0, s35, 65536
    s_nop 0
    buffer_load_dwordx4 v4, s[48:51], s41 offen lds
    s_add_u32 s41, s41, 57344
    s_waitcnt vmcnt(8)
    s_barrier
    v_mov_b32 v14, 1
    s_add_u32 s3, s38, 0
    buffer_store_dword v14, v12, s[8:11], s3 offen sc1
    s_add_u32 m0, s35, 69632
    s_nop 0
    buffer_load_dwordx4 v4, s[48:51], s41 offen lds
    s_add_u32 s41, s41, 57344
    s_add_u32 m0, s35, 73728
    s_nop 0
    buffer_load_dwordx4 v4, s[48:51], s41 offen lds
    s_add_u32 s41, s41, 57344
    s_add_u32 m0, s35, 77824
    s_nop 0
    buffer_load_dwordx4 v4, s[48:51], s41 offen lds
    s_add_u32 s41, s41, 57344
    s_add_u32 m0, s35, 81920
    s_nop 0
    buffer_load_dwordx4 v4, s[48:51], s41 offen lds
    s_add_u32 s41, s41, 57344
    s_add_u32 m0, s35, 86016
    s_nop 0
    buffer_load_dwordx4 v4, s[48:51], s41 offen lds
    s_add_u32 s41, s41, 57344
    s_add_u32 m0, s35, 90112
    s_nop 0
    buffer_load_dwordx4 v4, s[48:51], s41 offen lds
    s_add_u32 s41, s41, 57344
    s_add_u32 m0, s35, 94208
    s_nop 0
    buffer_load_dwordx4 v4, s[48:51], s41 offen lds
    s_add_u32 s41, s41, 57344
    s_add_u32 m0, s35, 98304
    s_nop 0
    buffer_load_dwordx4 v4, s[48:51], s41 offen lds
    s_add_u32 s41, s41, 57344
    s_add_u32 m0, s35, 102400
    s_nop 0
    buffer_load_dwordx4 v4, s[48:51], s41 offen lds
    s_add_u32 s41, s41, 57344
    s_add_u32 m0, s35, 106496
    s_nop 0
    buffer_load_dwordx4 v4, s[48:51], s41 offen lds
    s_add_u32 s41, s41, 57344
    s_add_u32 m0, s35, 110592
    s_nop 0
    buffer_load_dwordx4 v4, s[48:51], s41 offen lds
    s_add_u32 s41, s41, 57344
    s_add_u32 m0, s35, 114688
    s_nop 0
    buffer_load_dwordx4 v4, s[48:51], s41 offen lds
    s_add_u32 s41, s41, 57344
    s_mov_b32 s3, 2544896
    v_min_u32 v6, 223, v0
    v_lshlrev_b32 v9, 4, v6
    s_mov_b32 s55, 0
H_SBL:
    buffer_load_dwordx4 v[76:79], v9, s[8:11], s3 offen sc1
    s_waitcnt vmcnt(0)
    v_min3_u32 v10, v76, v77, v78
    v_min_u32 v10, v10, v79
    v_cmp_eq_u32 vcc, 0, v10
    s_add_u32 s55, s55, 1
    s_cbranch_vccz H_SBD
    s_sleep 12
    s_cmp_lt_u32 s55, 20000
    s_cbranch_scc1 H_SBL
H_SBD:
    s_mov_b32 s3, 0x07060302
    v_perm_b32 v76, v77, v76, s3
    v_perm_b32 v77, v79, v78, s3
    v_and_b32 v9, 1, v6
    v_bfe_u32 v10, v6, 1, 1
    v_and_b32 v6, 0xfc, v6
    v_lshl_add_u32 v6, v9, 1, v6
    v_add_u32 v6, v6, v10
    v_lshlrev_b32 v6, 3, v6
    v_bfe_u32 v9, v1, 2, 2
    v_xor_b32 v7, s30, v9
    v_lshlrev_b32 v10, 6, v7
    v_lshl_add_u32 v10, v9, 8, v10
    v_lshl_add_u32 v10, v8, 10, v10
    v_bfe_u32 v9, v1, 4, 1
    v_lshl_add_u32 v10, v9, 5, v10
    v_lshl_add_u32 v10, v5, 3, v10
    v_add_u32 v11, 61440, v10
    v_add_u32 v10, 4096, v10
    v_and_b32 v7, 1, v1
    v_xor_b32 v7, 1, v7
    v_mul_u32_u24 v7, 896, v7
    v_lshl_add_u32 v7, v8, 4, v7
    ds_write_b64 v6, v[76:77]
    s_waitcnt vmcnt(0) lgkmcnt(0)
    s_barrier
    ds_read_b128 v[16:19], v7
    ds_read_b64_tr_b16 v[80:81], v10
    ds_read_b64_tr_b16 v[82:83], v10 offset:2048
    ds_read_b128 v[20:23], v7 offset:32
    ds_read_b64_tr_b16 v[84:85], v10 offset:4096
    ds_read_b64_tr_b16 v[86:87], v10 offset:6144
    ds_read_b128 v[24:27], v7 offset:64
    ds_read_b64_tr_b16 v[88:89], v10 offset:8192
    ds_read_b64_tr_b16 v[90:91], v10 offset:10240
    ds_read_b128 v[28:31], v7 offset:96
    ds_read_b64_tr_b16 v[92:93], v10 offset:12288
    ds_read_b64_tr_b16 v[94:95], v10 offset:14336
    s_waitcnt lgkmcnt(9)
    v_mfma_f32_32x32x16_bf16 v[240:255], v[16:19], v[80:83], 0
    ds_read_b128 v[32:35], v7 offset:128
    ds_read_b64_tr_b16 v[96:97], v10 offset:16384
    ds_read_b64_tr_b16 v[98:99], v10 offset:18432
    buffer_store_dwordx4 v[64:67], v75, s[8:11], s45 offen sc1
    s_waitcnt lgkmcnt(9)
    v_mfma_f32_32x32x16_bf16 v[240:255], v[20:23], v[84:87], v[240:255]
    ds_read_b128 v[36:39], v7 offset:160
    ds_read_b64_tr_b16 v[100:101], v10 offset:20480
    ds_read_b64_tr_b16 v[102:103], v10 offset:22528
    buffer_store_dwordx4 v[64:67], v75, s[8:11], s45 offen offset:1024 sc1
    s_add_u32 s45, s45, s46
    s_waitcnt lgkmcnt(9)
    v_mfma_f32_32x32x16_bf16 v[240:255], v[24:27], v[88:91], v[240:255]
    ds_read_b128 v[40:43], v7 offset:192
    ds_read_b64_tr_b16 v[104:105], v10 offset:24576
    ds_read_b64_tr_b16 v[106:107], v10 offset:26624
    buffer_store_dwordx4 v[64:67], v75, s[8:11], s45 offen sc1
    s_waitcnt lgkmcnt(9)
    v_mfma_f32_32x32x16_bf16 v[240:255], v[28:31], v[92:95], v[240:255]
    ds_read_b128 v[44:47], v7 offset:224
    ds_read_b64_tr_b16 v[108:109], v10 offset:28672
    ds_read_b64_tr_b16 v[110:111], v10 offset:30720
    buffer_store_dwordx4 v[64:67], v75, s[8:11], s45 offen offset:1024 sc1
    s_add_u32 s45, s45, 114688
    s_waitcnt lgkmcnt(9)
    v_mfma_f32_32x32x16_bf16 v[240:255], v[32:35], v[96:99], v[240:255]
    ds_read_b128 v[16:19], v7 offset:256
    ds_read_b64_tr_b16 v[80:81], v10 offset:32768
    ds_read_b64_tr_b16 v[82:83], v10 offset:34816
    buffer_store_dwordx4 v[64:67], v75, s[8:11], s45 offen sc1
    s_waitcnt lgkmcnt(9)
    v_mfma_f32_32x32x16_bf16 v[240:255], v[36:39], v[100:103], v[240:255]
    ds_read_b128 v[20:23], v7 offset:288
    ds_read_b64_tr_b16 v[84:85], v10 offset:36864
    ds_read_b64_tr_b16 v[86:87], v10 offset:38912
    buffer_store_dwordx4 v[64:67], v75, s[8:11], s45 offen offset:1024 sc1
    s_add_u32 s45, s45, s47
    s_waitcnt lgkmcnt(9)
    v_mfma_f32_32x32x16_bf16 v[240:255], v[40:43], v[104:107], v[240:255]
    ds_read_b128 v[24:27], v7 offset:320
    ds_read_b64_tr_b16 v[88:89], v10 offset:40960
    ds_read_b64_tr_b16 v[90:91], v10 offset:43008
    buffer_store_dwordx4 v[64:67], v75, s[8:11], s45 offen sc1
    s_waitcnt lgkmcnt(9)
    v_mfma_f32_32x32x16_bf16 v[240:255], v[44:47], v[108:111], v[240:255]
    ds_read_b128 v[28:31], v7 offset:352
    ds_read_b64_tr_b16 v[92:93], v10 offset:45056
    ds_read_b64_tr_b16 v[94:95], v10 offset:47104
    buffer_store_dwordx4 v[64:67], v75, s[8:11], s45 offen offset:1024 sc1
    s_add_u32 s45, s45, s46
    s_waitcnt lgkmcnt(9)
    v_mfma_f32_32x32x16_bf16 v[240:255], v[16:19], v[80:83], v[240:255]
    ds_read_b128 v[32:35], v7 offset:384
    ds_read_b64_tr_b16 v[96:97], v10 offset:49152
    ds_read_b64_tr_b16 v[98:99], v10 offset:51200
    buffer_store_dwordx4 v[64:67], v75, s[8:11], s45 offen sc1
    s_waitcnt lgkmcnt(9)
    v_mfma_f32_32x32x16_bf16 v[240:255], v[20:23], v[84:87], v[240:255]
    ds_read_b128 v[36:39], v7 offset:416
    ds_read_b64_tr_b16 v[100:101], v10 offset:53248
    ds_read_b64_tr_b16 v[102:103], v10 offset:55296
    buffer_store_dwordx4 v[64:67], v75, s[8:11], s45 offen offset:1024 sc1
    s_add_u32 s45, s45, 114688
    s_waitcnt lgkmcnt(9)
    v_mfma_f32_32x32x16_bf16 v[240:255], v[24:27], v[88:91], v[240:255]
    ds_read_b128 v[40:43], v7 offset:448
    ds_read_b64_tr_b16 v[104:105], v11
    ds_read_b64_tr_b16 v[106:107], v11 offset:2048
    buffer_store_dwordx4 v[64:67], v75, s[8:11], s45 offen sc1
    s_waitcnt lgkmcnt(9)
    v_mfma_f32_32x32x16_bf16 v[240:255], v[28:31], v[92:95], v[240:255]
    ds_read_b128 v[44:47], v7 offset:480
    ds_read_b64_tr_b16 v[108:109], v11 offset:4096
    ds_read_b64_tr_b16 v[110:111], v11 offset:6144
    buffer_store_dwordx4 v[64:67], v75, s[8:11], s45 offen offset:1024 sc1
    s_add_u32 s45, s45, s47
    s_waitcnt lgkmcnt(9)
    v_mfma_f32_32x32x16_bf16 v[240:255], v[32:35], v[96:99], v[240:255]
    ds_read_b128 v[16:19], v7 offset:512
    ds_read_b64_tr_b16 v[80:81], v11 offset:8192
    ds_read_b64_tr_b16 v[82:83], v11 offset:10240
    s_waitcnt lgkmcnt(9)
    v_mfma_f32_32x32x16_bf16 v[240:255], v[36:39], v[100:103], v[240:255]
    ds_read_b128 v[20:23], v7 offset:544
    ds_read_b64_tr_b16 v[84:85], v11 offset:12288
    ds_read_b64_tr_b16 v[86:87], v11 offset:14336
    s_waitcnt lgkmcnt(9)
    v_mfma_f32_32x32x16_bf16 v[240:255], v[40:43], v[104:107], v[240:255]
    ds_read_b128 v[24:27], v7 offset:576
    ds_read_b64_tr_b16 v[88:89], v11 offset:16384
    ds_read_b64_tr_b16 v[90:91], v11 offset:18432
    s_waitcnt lgkmcnt(9)
    v_mfma_f32_32x32x16_bf16 v[240:255], v[44:47], v[108:111], v[240:255]
    ds_read_b128 v[28:31], v7 offset:608
    ds_read_b64_tr_b16 v[92:93], v11 offset:20480
    ds_read_b64_tr_b16 v[94:95], v11 offset:22528
    s_waitcnt lgkmcnt(9)
    v_mfma_f32_32x32x16_bf16 v[240:255], v[16:19], v[80:83], v[240:255]
    ds_read_b128 v[32:35], v7 offset:640
    ds_read_b64_tr_b16 v[96:97], v11 offset:24576
    ds_read_b64_tr_b16 v[98:99], v11 offset:26624
    s_waitcnt lgkmcnt(9)
    v_mfma_f32_32x32x16_bf16 v[240:255], v[20:23], v[84:87], v[240:255]
    ds_read_b128 v[36:39], v7 offset:672
    ds_read_b64_tr_b16 v[100:101], v11 offset:28672
    ds_read_b64_tr_b16 v[102:103], v11 offset:30720
    s_waitcnt lgkmcnt(9)
    v_mfma_f32_32x32x16_bf16 v[240:255], v[24:27], v[88:91], v[240:255]
    ds_read_b128 v[40:43], v7 offset:704
    ds_read_b64_tr_b16 v[104:105], v11 offset:32768
    ds_read_b64_tr_b16 v[106:107], v11 offset:34816
    s_waitcnt lgkmcnt(9)
    v_mfma_f32_32x32x16_bf16 v[240:255], v[28:31], v[92:95], v[240:255]
    ds_read_b128 v[44:47], v7 offset:736
    ds_read_b64_tr_b16 v[108:109], v11 offset:36864
    ds_read_b64_tr_b16 v[110:111], v11 offset:38912
    s_waitcnt lgkmcnt(9)
    v_mfma_f32_32x32x16_bf16 v[240:255], v[32:35], v[96:99], v[240:255]
    ds_read_b128 v[16:19], v7 offset:768
    ds_read_b64_tr_b16 v[80:81], v11 offset:40960
    ds_read_b64_tr_b16 v[82:83], v11 offset:43008
    s_waitcnt lgkmcnt(9)
    v_mfma_f32_32x32x16_bf16 v[240:255], v[36:39], v[100:103], v[240:255]
    ds_read_b128 v[20:23], v7 offset:800
    ds_read_b64_tr_b16 v[84:85], v11 offset:45056
    ds_read_b64_tr_b16 v[86:87], v11 offset:47104
    s_waitcnt lgkmcnt(9)
    v_mfma_f32_32x32x16_bf16 v[240:255], v[40:43], v[104:107], v[240:255]
    ds_read_b128 v[24:27], v7 offset:832
    ds_read_b64_tr_b16 v[88:89], v11 offset:49152
    ds_read_b64_tr_b16 v[90:91], v11 offset:51200
    s_waitcnt lgkmcnt(9)
    v_mfma_f32_32x32x16_bf16 v[240:255], v[44:47], v[108:111], v[240:255]
    ds_read_b128 v[28:31], v7 offset:864
    ds_read_b64_tr_b16 v[92:93], v11 offset:53248
    ds_read_b64_tr_b16 v[94:95], v11 offset:55296
    s_waitcnt lgkmcnt(9)
    v_mfma_f32_32x32x16_bf16 v[240:255], v[16:19], v[80:83], v[240:255]
    s_waitcnt lgkmcnt(6)
    v_mfma_f32_32x32x16_bf16 v[240:255], v[20:23], v[84:87], v[240:255]
    s_waitcnt lgkmcnt(3)
    v_mfma_f32_32x32x16_bf16 v[240:255], v[24:27], v[88:91], v[240:255]
    s_waitcnt lgkmcnt(0)
    v_mfma_f32_32x32x16_bf16 v[240:255], v[28:31], v[92:95], v[240:255]
    s_nop 11
    v_cvt_pk_bf16_f32 v17, v240, v241
    v_lshlrev_b32 v20, 16, v17
    v_and_b32 v21, 0xffff0000, v17
    v_sub_f32 v22, v240, v20
    v_sub_f32 v23, v241, v21
    v_cvt_pk_bf16_f32 v16, v20, v22
    v_cvt_pk_bf16_f32 v18, v23, v21
    v_mov_b32 v19, 0
    buffer_store_dwordx4 v[16:19], v63, s[8:11], s42 offen sc1
    buffer_store_dwordx4 v[64:67], v75, s[8:11], s45 offen sc1
    buffer_store_dwordx4 v[64:67], v75, s[8:11], s45 offen offset:1024 sc1
    s_add_u32 s45, s45, s46
    buffer_store_dwordx4 v[64:67], v75, s[8:11], s45 offen sc1
    buffer_store_dwordx4 v[64:67], v75, s[8:11], s45 offen offset:1024 sc1
    s_add_u32 s45, s45, 114688
    buffer_store_dwordx4 v[64:67], v75, s[8:11], s45 offen sc1
    buffer_store_dwordx4 v[64:67], v75, s[8:11], s45 offen offset:1024 sc1
    s_add_u32 s45, s45, s47
    buffer_store_dwordx4 v[64:67], v75, s[8:11], s45 offen sc1
    buffer_store_dwordx4 v[64:67], v75, s[8:11], s45 offen offset:1024 sc1
    s_add_u32 s45, s45, s46
    buffer_store_dwordx4 v[64:67], v75, s[8:11], s45 offen sc1
    buffer_store_dwordx4 v[64:67], v75, s[8:11], s45 offen offset:1024 sc1
    s_add_u32 s45, s45, 114688
    buffer_store_dwordx4 v[64:67], v75, s[8:11], s45 offen sc1
    buffer_store_dwordx4 v[64:67], v75, s[8:11], s45 offen offset:1024 sc1
    s_add_u32 s45, s45, s47
    buffer_store_dwordx4 v[64:67], v75, s[8:11], s45 offen sc1
    buffer_store_dwordx4 v[64:67], v75, s[8:11], s45 offen offset:1024 sc1
    s_add_u32 s45, s45, s46
    buffer_store_dwordx4 v[64:67], v75, s[8:11], s45 offen sc1
    buffer_store_dwordx4 v[64:67], v75, s[8:11], s45 offen offset:1024 sc1
    s_add_u32 s45, s45, 114688
    buffer_store_dwordx4 v[64:67], v75, s[8:11], s45 offen sc1
    buffer_store_dwordx4 v[64:67], v75, s[8:11], s45 offen offset:1024 sc1
    s_add_u32 s45, s45, s47
    buffer_store_dwordx4 v[64:67], v75, s[8:11], s45 offen sc1
    buffer_store_dwordx4 v[64:67], v75, s[8:11], s45 offen offset:1024 sc1
    s_add_u32 s45, s45, s46
    buffer_store_dwordx4 v[64:67], v75, s[8:11], s45 offen sc1
    buffer_store_dwordx4 v[64:67], v75, s[8:11], s45 offen offset:1024 sc1
    s_add_u32 s45, s45, 114688
    buffer_store_dwordx4 v[64:67], v75, s[8:11], s45 offen sc1
    buffer_store_dwordx4 v[64:67], v75, s[8:11], s45 offen offset:1024 sc1
    s_add_u32 s45, s45, s47
    buffer_store_dwordx4 v[64:67], v75, s[8:11], s45 offen sc1
    buffer_store_dwordx4 v[64:67], v75, s[8:11], s45 offen offset:1024 sc1
    s_add_u32 s45, s45, s46
    buffer_store_dwordx4 v[64:67], v75, s[8:11], s45 offen sc1
    buffer_store_dwordx4 v[64:67], v75, s[8:11], s45 offen offset:1024 sc1
    s_add_u32 s45, s45, 114688
    buffer_store_dwordx4 v[64:67], v75, s[8:11], s45 offen sc1
    buffer_store_dwordx4 v[64:67], v75, s[8:11], s45 offen offset:1024 sc1
    s_add_u32 s45, s45, s47
    s_lshl_b32 s3, s2, 2
    s_add_u32 s3, s3, s30
    s_lshl_b32 s3, s3, 6
    s_add_u32 s3, s3, 2560000
    v_min_u32 v12, 1, v1
    v_lshlrev_b32 v12, 30, v12
    v_mov_b32 v14, 1
    s_waitcnt vmcnt(0)
    buffer_store_dword v14, v12, s[8:11], s3 offen sc1
H_DUMP:
K_END:
K_LAST:
    s_endpgm
CHK5S:
    s_mov_b32 s55, 0
POLL11:
    buffer_load_dword v7, v6, s[8:11], s58 offen sc1
    s_add_u32 s55, s55, 1
    s_waitcnt vmcnt(0)
    v_cmp_gt_u32 vcc, 1, v7
    s_nop 0
    s_and_b32 vcc_lo, vcc_lo, 127
    s_cbranch_scc0 POLL11D
    s_cmp_lt_u32 s55, 20000
    s_cbranch_scc1 POLL11
POLL11D:
    s_branch CHK5
SLOWE:
    s_mov_b32 s55, 0
SPINE:
    buffer_load_dwordx4 v[184:187], v10, s[8:11], s4 offen sc1
    s_waitcnt vmcnt(0)
    v_max3_u32 v12, v184, v185, v186
    v_max_u32 v12, v12, v187
    v_cmp_eq_u32 vcc, -1, v12
    s_add_u32 s55, s55, 1
    s_cbranch_vccz BACKE
    s_cmp_lt_u32 s55, 20000
    s_cbranch_scc1 SPINE
    s_branch BACKE
CHK8S:
    s_mov_b32 s55, 0
POLL12:
    buffer_load_dword v12, v13, s[8:11], s13 offen sc1
    s_add_u32 s55, s55, 1
    s_waitcnt vmcnt(0)
    v_cmp_gt_u32 vcc, 1, v12
    s_nop 0
    s_and_b32 vcc_lo, vcc_lo, 1
    s_cbranch_scc0 POLL12D
    s_cmp_lt_u32 s55, 20000
    s_cbranch_scc1 POLL12
POLL12D:
    s_branch CHK8
CHK9S:
    s_mov_b32 s55, 0
POLL13:
    buffer_load_dword v14, v6, s[8:11], s12 offen sc1
    s_add_u32 s55, s55, 1
    s_waitcnt vmcnt(0)
    v_cmp_gt_u32 vcc, 1, v14
    s_nop 0
    s_and_b32 vcc_lo, vcc_lo, 16383
    s_cbranch_scc0 POLL13D
    s_cmp_lt_u32 s55, 20000
    s_cbranch_scc1 POLL13
POLL13D:
    s_branch CHK9
SLOWS2:
    s_mov_b32 s55, 0
SPINS2:
    buffer_load_dword v12, v5, s[8:11], s35 offen offset:2044 sc1
    s_waitcnt vmcnt(0)
    v_cmp_eq_u32 vcc, -1, v12
    s_add_u32 s55, s55, 1
    s_cbranch_vccz SPIND2
    s_cmp_lt_u32 s55, 20000
    s_cbranch_scc1 SPINS2
SPIND2:
    s_add_u32 s3, s35, s24
    buffer_load_dwordx4 a[56:59], v2, s[8:11], s3 offen sc1
    buffer_load_dwordx4 a[60:63], v2, s[8:11], s3 offen offset:1024 sc1
    s_add_u32 s3, s35, s25
    buffer_load_dwordx4 a[64:67], v2, s[8:11], s3 offen sc1
    buffer_load_dwordx4 a[68:71], v2, s[8:11], s3 offen offset:1024 sc1
    s_add_u32 s3, s35, s26
    buffer_load_dwordx4 a[72:75], v2, s[8:11], s3 offen sc1
    buffer_load_dwordx4 a[76:79], v2, s[8:11], s3 offen offset:1024 sc1
    s_add_u32 s3, s35, s27
    buffer_load_dwordx4 a[80:83], v2, s[8:11], s3 offen sc1
    buffer_load_dwordx4 a[84:87], v2, s[8:11], s3 offen offset:1024 sc1
    s_add_u32 s3, s35, s33
    buffer_load_dwordx4 a[88:91], v2, s[8:11], s3 offen sc1
    buffer_load_dwordx4 a[92:95], v2, s[8:11], s3 offen offset:1024 sc1
    s_add_u32 s3, s35, s38
    buffer_load_dwordx4 a[96:99], v2, s[8:11], s3 offen sc1
    buffer_load_dwordx4 a[100:103], v2, s[8:11], s3 offen offset:1024 sc1
    s_add_u32 s3, s35, s32
    buffer_load_dwordx4 a[104:107], v2, s[8:11], s3 offen sc1
    buffer_load_dwordx4 a[108:111], v2, s[8:11], s3 offen offset:1024 sc1
    s_waitcnt vmcnt(0)
    s_branch BACKS2
SLOWS3:
    s_mov_b32 s55, 0
SPINS3:
    buffer_load_dword v14, v5, s[8:11], s53 offen offset:2044 sc1
    s_waitcnt vmcnt(0)
    v_cmp_eq_u32 vcc, -1, v14
    s_add_u32 s55, s55, 1
    s_cbranch_vccz SPIND3
    s_cmp_lt_u32 s55, 20000
    s_cbranch_scc1 SPINS3
SPIND3:
    s_add_u32 s3, s53, s24
    buffer_load_dwordx4 a[0:3], v2, s[8:11], s3 offen sc1
    buffer_load_dwordx4 a[4:7], v2, s[8:11], s3 offen offset:1024 sc1
    s_add_u32 s3, s53, s25
    buffer_load_dwordx4 a[8:11], v2, s[8:11], s3 offen sc1
    buffer_load_dwordx4 a[12:15], v2, s[8:11], s3 offen offset:1024 sc1
    s_add_u32 s3, s53, s26
    buffer_load_dwordx4 a[16:19], v2, s[8:11], s3 offen sc1
    buffer_load_dwordx4 a[20:23], v2, s[8:11], s3 offen offset:1024 sc1
    s_add_u32 s3, s53, s27
    buffer_load_dwordx4 a[24:27], v2, s[8:11], s3 offen sc1
    buffer_load_dwordx4 a[28:31], v2, s[8:11], s3 offen offset:1024 sc1
    s_add_u32 s3, s53, s33
    buffer_load_dwordx4 a[32:35], v2, s[8:11], s3 offen sc1
    buffer_load_dwordx4 a[36:39], v2, s[8:11], s3 offen offset:1024 sc1
    s_add_u32 s3, s53, s38
    buffer_load_dwordx4 a[40:43], v2, s[8:11], s3 offen sc1
    buffer_load_dwordx4 a[44:47], v2, s[8:11], s3 offen offset:1024 sc1
    s_add_u32 s3, s53, s32
    buffer_load_dwordx4 a[48:51], v2, s[8:11], s3 offen sc1
    buffer_load_dwordx4 a[52:55], v2, s[8:11], s3 offen offset:1024 sc1
    s_waitcnt vmcnt(0)
    s_branch BACKS3
SLOWN0:
    s_mov_b32 s55, 0
REDO0:
    s_nop 15
    s_add_u32 s3, s35, s24
    buffer_load_dwordx4 a[56:59], v2, s[8:11], s3 offen sc1
    buffer_load_dwordx4 a[60:63], v2, s[8:11], s3 offen offset:1024 sc1
    s_add_u32 s3, s35, s25
    buffer_load_dwordx4 a[64:67], v2, s[8:11], s3 offen sc1
    buffer_load_dwordx4 a[68:71], v2, s[8:11], s3 offen offset:1024 sc1
    s_add_u32 s3, s35, s26
    buffer_load_dwordx4 a[72:75], v2, s[8:11], s3 offen sc1
    buffer_load_dwordx4 a[76:79], v2, s[8:11], s3 offen offset:1024 sc1
    s_add_u32 s3, s35, s27
    buffer_load_dwordx4 a[80:83], v2, s[8:11], s3 offen sc1
    buffer_load_dwordx4 a[84:87], v2, s[8:11], s3 offen offset:1024 sc1
    s_add_u32 s3, s35, s33
    buffer_load_dwordx4 a[88:91], v2, s[8:11], s3 offen sc1
    buffer_load_dwordx4 a[92:95], v2, s[8:11], s3 offen offset:1024 sc1
    s_add_u32 s3, s35, s38
    buffer_load_dwordx4 a[96:99], v2, s[8:11], s3 offen sc1
    buffer_load_dwordx4 a[100:103], v2, s[8:11], s3 offen offset:1024 sc1
    s_add_u32 s3, s35, s32
    buffer_load_dwordx4 a[104:107], v2, s[8:11], s3 offen sc1
    buffer_load_dwordx4 a[108:111], v2, s[8:11], s3 offen offset:1024 sc1
    s_waitcnt vmcnt(0) lgkmcnt(0)
    v_mfma_f32_16x16x32_bf16 v[80:83], a[112:115], a[56:59], v[16:19]
    v_mfma_f32_16x16x32_bf16 v[80:83], a[128:131], a[64:67], v[80:83]
    v_mfma_f32_16x16x32_bf16 v[84:87], a[112:115], a[60:63], v[20:23]
    v_mfma_f32_16x16x32_bf16 v[84:87], a[128:131], a[68:71], v[84:87]
    v_mfma_f32_16x16x32_bf16 v[88:91], a[116:119], a[56:59], v[24:27]
    v_mfma_f32_16x16x32_bf16 v[88:91], a[132:135], a[64:67], v[88:91]
    v_mfma_f32_16x16x32_bf16 v[92:95], a[116:119], a[60:63], v[28:31]
    v_mfma_f32_16x16x32_bf16 v[92:95], a[132:135], a[68:71], v[92:95]
    v_mfma_f32_16x16x32_bf16 v[96:99], a[120:123], a[56:59], v[32:35]
    v_mfma_f32_16x16x32_bf16 v[96:99], a[136:139], a[64:67], v[96:99]
    v_mfma_f32_16x16x32_bf16 v[100:103], a[120:123], a[60:63], v[36:39]
    v_mfma_f32_16x16x32_bf16 v[100:103], a[136:139], a[68:71], v[100:103]
    v_mfma_f32_16x16x32_bf16 v[104:107], a[124:127], a[56:59], v[40:43]
    v_mfma_f32_16x16x32_bf16 v[104:107], a[140:143], a[64:67], v[104:107]
    v_mfma_f32_16x16x32_bf16 v[108:111], a[124:127], a[60:63], v[44:47]
    v_mfma_f32_16x16x32_bf16 v[108:111], a[140:143], a[68:71], v[108:111]
    v_mfma_f32_16x16x32_bf16 v[80:83], a[144:147], a[72:75], v[80:83]
    v_mfma_f32_16x16x32_bf16 v[80:83], a[160:163], a[80:83], v[80:83]
    v_mfma_f32_16x16x32_bf16 v[84:87], a[144:147], a[76:79], v[84:87]
    v_mfma_f32_16x16x32_bf16 v[84:87], a[160:163], a[84:87], v[84:87]
    v_mfma_f32_16x16x32_bf16 v[88:91], a[148:151], a[72:75], v[88:91]
    v_mfma_f32_16x16x32_bf16 v[88:91], a[164:167], a[80:83], v[88:91]
    v_mfma_f32_16x16x32_bf16 v[92:95], a[148:151], a[76:79], v[92:95]
    v_mfma_f32_16x16x32_bf16 v[92:95], a[164:167], a[84:87], v[92:95]
    v_mfma_f32_16x16x32_bf16 v[96:99], a[152:155], a[72:75], v[96:99]
    v_mfma_f32_16x16x32_bf16 v[96:99], a[168:171], a[80:83], v[96:99]
    v_mfma_f32_16x16x32_bf16 v[100:103], a[152:155], a[76:79], v[100:103]
    v_mfma_f32_16x16x32_bf16 v[100:103], a[168:171], a[84:87], v[100:103]
    v_mfma_f32_16x16x32_bf16 v[104:107], a[156:159], a[72:75], v[104:107]
    v_mfma_f32_16x16x32_bf16 v[104:107], a[172:175], a[80:83], v[104:107]
    v_mfma_f32_16x16x32_bf16 v[108:111], a[156:159], a[76:79], v[108:111]
    v_mfma_f32_16x16x32_bf16 v[108:111], a[172:175], a[84:87], v[108:111]
    v_mfma_f32_16x16x32_bf16 v[80:83], a[176:179], a[88:91], v[80:83]
    v_mfma_f32_16x16x32_bf16 v[80:83], a[192:195], a[96:99], v[80:83]
    v_mfma_f32_16x16x32_bf16 v[80:83], a[208:211], a[104:107], v[80:83]
    v_mfma_f32_16x16x32_bf16 v[84:87], a[176:179], a[92:95], v[84:87]
    v_mfma_f32_16x16x32_bf16 v[84:87], a[192:195], a[100:103], v[84:87]
    v_mfma_f32_16x16x32_bf16 v[84:87], a[208:211], a[108:111], v[84:87]
    v_mfma_f32_16x16x32_bf16 v[88:91], a[180:183], a[88:91], v[88:91]
    v_mfma_f32_16x16x32_bf16 v[88:91], a[196:199], a[96:99], v[88:91]
    v_mfma_f32_16x16x32_bf16 v[88:91], a[212:215], a[104:107], v[88:91]
    v_mfma_f32_16x16x32_bf16 v[92:95], a[180:183], a[92:95], v[92:95]
    v_mfma_f32_16x16x32_bf16 v[92:95], a[196:199], a[100:103], v[92:95]
    v_mfma_f32_16x16x32_bf16 v[92:95], a[212:215], a[108:111], v[92:95]
    v_mfma_f32_16x16x32_bf16 v[96:99], a[184:187], a[88:91], v[96:99]
    v_mfma_f32_16x16x32_bf16 v[96:99], a[200:203], a[96:99], v[96:99]
    v_mfma_f32_16x16x32_bf16 v[96:99], a[216:219], a[104:107], v[96:99]
    v_mfma_f32_16x16x32_bf16 v[100:103], a[184:187], a[92:95], v[100:103]
    v_mfma_f32_16x16x32_bf16 v[100:103], a[200:203], a[100:103], v[100:103]
    v_mfma_f32_16x16x32_bf16 v[100:103], a[216:219], a[108:111], v[100:103]
    v_mfma_f32_16x16x32_bf16 v[104:107], a[188:191], a[88:91], v[104:107]
    v_mfma_f32_16x16x32_bf16 v[104:107], a[204:207], a[96:99], v[104:107]
    v_mfma_f32_16x16x32_bf16 v[104:107], a[220:223], a[104:107], v[104:107]
    v_mfma_f32_16x16x32_bf16 v[108:111], a[188:191], a[92:95], v[108:111]
    v_mfma_f32_16x16x32_bf16 v[108:111], a[204:207], a[100:103], v[108:111]
    v_mfma_f32_16x16x32_bf16 v[108:111], a[220:223], a[108:111], v[108:111]
    s_nop 15
    v_cmp_u_f32 vcc, v80, v84
    s_add_u32 s55, s55, 1
    s_cbranch_vccz REDOD0
    s_cmp_lt_u32 s55, 64
    s_cbranch_scc1 REDO0
REDOD0:
    s_branch BACKN0
SLOWG:
    s_mov_b32 s55, 0
SPING:
    buffer_load_dwordx4 v[160:163], v6, s[8:11], s5 offen sc1
    s_waitcnt vmcnt(0)
    v_min3_u32 v15, v160, v161, v162
    v_min_u32 v15, v15, v163
    v_cmp_eq_u32 vcc, 0, v15
    s_add_u32 s55, s55, 1
    s_cbranch_vccz BACKG
    s_cmp_lt_u32 s55, 20000
    s_cbranch_scc1 SPING
    s_branch BACKG
SLOWS4:
    s_mov_b32 s55, 0
SPINS4:
    buffer_load_dword v12, v5, s[8:11], s35 offen offset:2044 sc1
    s_waitcnt vmcnt(0)
    v_cmp_eq_u32 vcc, -1, v12
    s_add_u32 s55, s55, 1
    s_cbranch_vccz SPIND4
    s_cmp_lt_u32 s55, 20000
    s_cbranch_scc1 SPINS4
SPIND4:
    s_add_u32 s3, s35, s24
    buffer_load_dwordx4 a[56:59], v2, s[8:11], s3 offen sc1
    buffer_load_dwordx4 a[60:63], v2, s[8:11], s3 offen offset:1024 sc1
    s_add_u32 s3, s35, s25
    buffer_load_dwordx4 a[64:67], v2, s[8:11], s3 offen sc1
    buffer_load_dwordx4 a[68:71], v2, s[8:11], s3 offen offset:1024 sc1
    s_add_u32 s3, s35, s26
    buffer_load_dwordx4 a[72:75], v2, s[8:11], s3 offen sc1
    buffer_load_dwordx4 a[76:79], v2, s[8:11], s3 offen offset:1024 sc1
    s_add_u32 s3, s35, s27
    buffer_load_dwordx4 a[80:83], v2, s[8:11], s3 offen sc1
    buffer_load_dwordx4 a[84:87], v2, s[8:11], s3 offen offset:1024 sc1
    s_add_u32 s3, s35, s33
    buffer_load_dwordx4 a[88:91], v2, s[8:11], s3 offen sc1
    buffer_load_dwordx4 a[92:95], v2, s[8:11], s3 offen offset:1024 sc1
    s_add_u32 s3, s35, s38
    buffer_load_dwordx4 a[96:99], v2, s[8:11], s3 offen sc1
    buffer_load_dwordx4 a[100:103], v2, s[8:11], s3 offen offset:1024 sc1
    s_add_u32 s3, s35, s32
    buffer_load_dwordx4 a[104:107], v2, s[8:11], s3 offen sc1
    buffer_load_dwordx4 a[108:111], v2, s[8:11], s3 offen offset:1024 sc1
    s_waitcnt vmcnt(13)
    v_mfma_f32_16x16x32_bf16 v[48:51], a[112:115], a[56:59], v[48:51]
    ds_read_b128 v[36:39], v10 offset:7168
    s_waitcnt vmcnt(11)
    v_mfma_f32_16x16x32_bf16 v[48:51], a[128:131], a[64:67], v[48:51]
    v_mfma_f32_16x16x32_bf16 v[52:55], a[112:115], a[60:63], v[52:55]
    s_waitcnt vmcnt(10)
    v_mfma_f32_16x16x32_bf16 v[52:55], a[128:131], a[68:71], v[52:55]
    v_mfma_f32_16x16x32_bf16 v[56:59], a[116:119], a[56:59], v[56:59]
    v_mfma_f32_16x16x32_bf16 v[56:59], a[132:135], a[64:67], v[56:59]
    v_mfma_f32_16x16x32_bf16 v[60:63], a[116:119], a[60:63], v[60:63]
    s_waitcnt lgkmcnt(9)
    v_fmac_f32 v192, v160, v104
    v_fmac_f32 v193, v161, v105
    v_mfma_f32_16x16x32_bf16 v[60:63], a[132:135], a[68:71], v[60:63]
    v_fmac_f32 v194, v162, v106
    v_fmac_f32 v195, v163, v107
    v_mfma_f32_16x16x32_bf16 v[64:67], a[120:123], a[56:59], v[64:67]
    s_waitcnt lgkmcnt(8)
    v_fmac_f32 v196, v160, v108
    v_fmac_f32 v197, v161, v109
    v_mfma_f32_16x16x32_bf16 v[64:67], a[136:139], a[64:67], v[64:67]
    v_fmac_f32 v198, v162, v110
    v_fmac_f32 v199, v163, v111
    v_mfma_f32_16x16x32_bf16 v[68:71], a[120:123], a[60:63], v[68:71]
    s_waitcnt lgkmcnt(3)
    v_add_f32 v16, v16, v24
    v_add_f32 v17, v17, v25
    v_mfma_f32_16x16x32_bf16 v[68:71], a[136:139], a[68:71], v[68:71]
    v_add_f32 v18, v18, v26
    v_add_f32 v19, v19, v27
    v_mfma_f32_16x16x32_bf16 v[72:75], a[124:127], a[56:59], v[72:75]
    s_waitcnt lgkmcnt(2)
    v_add_f32 v20, v20, v28
    v_add_f32 v21, v21, v29
    v_mfma_f32_16x16x32_bf16 v[72:75], a[140:143], a[64:67], v[72:75]
    v_add_f32 v22, v22, v30
    v_add_f32 v23, v23, v31
    v_mfma_f32_16x16x32_bf16 v[76:79], a[124:127], a[60:63], v[76:79]
    s_waitcnt lgkmcnt(1)
    v_add_f32 v16, v16, v32
    v_add_f32 v17, v17, v33
    v_mfma_f32_16x16x32_bf16 v[76:79], a[140:143], a[68:71], v[76:79]
    v_add_f32 v18, v18, v34
    v_add_f32 v19, v19, v35
    s_waitcnt vmcnt(9)
    v_mfma_f32_16x16x32_bf16 v[48:51], a[144:147], a[72:75], v[48:51]
    s_waitcnt lgkmcnt(0)
    v_add_f32 v20, v20, v36
    v_add_f32 v21, v21, v37
    s_waitcnt vmcnt(7)
    v_mfma_f32_16x16x32_bf16 v[48:51], a[160:163], a[80:83], v[48:51]
    v_add_f32 v22, v22, v38
    v_add_f32 v23, v23, v39
    v_mfma_f32_16x16x32_bf16 v[52:55], a[144:147], a[76:79], v[52:55]
    v_fmac_f32 v192, v160, v16
    v_fmac_f32 v193, v161, v17
    s_waitcnt vmcnt(6)
    v_mfma_f32_16x16x32_bf16 v[52:55], a[160:163], a[84:87], v[52:55]
    v_fmac_f32 v194, v162, v18
    v_fmac_f32 v195, v163, v19
    v_mfma_f32_16x16x32_bf16 v[56:59], a[148:151], a[72:75], v[56:59]
    v_fmac_f32 v196, v160, v20
    v_fmac_f32 v197, v161, v21
    v_mfma_f32_16x16x32_bf16 v[56:59], a[164:167], a[80:83], v[56:59]
    v_fmac_f32 v198, v162, v22
    v_fmac_f32 v199, v163, v23
    v_mfma_f32_16x16x32_bf16 v[60:63], a[148:151], a[76:79], v[60:63]
    v_cvt_pk_bf16_f32 v168, v192, v193
    v_cvt_pk_bf16_f32 v170, v196, v197
    v_mfma_f32_16x16x32_bf16 v[60:63], a[164:167], a[84:87], v[60:63]
    v_cvt_pk_bf16_f32 v169, v194, v195
    v_cvt_pk_bf16_f32 v171, v198, v199
    v_mfma_f32_16x16x32_bf16 v[64:67], a[152:155], a[72:75], v[64:67]
    v_permlane16_swap_b32 v168, v170
    v_permlane16_swap_b32 v169, v171
    v_mfma_f32_16x16x32_bf16 v[64:67], a[168:171], a[80:83], v[64:67]
    buffer_store_dwordx4 v[168:171], v8, s[20:23], s6 offen
    v_mfma_f32_16x16x32_bf16 v[68:71], a[152:155], a[76:79], v[68:71]
    v_mfma_f32_16x16x32_bf16 v[68:71], a[168:171], a[84:87], v[68:71]
    v_mfma_f32_16x16x32_bf16 v[72:75], a[156:159], a[72:75], v[72:75]
    v_mfma_f32_16x16x32_bf16 v[72:75], a[172:175], a[80:83], v[72:75]
    v_mfma_f32_16x16x32_bf16 v[76:79], a[156:159], a[76:79], v[76:79]
    v_mfma_f32_16x16x32_bf16 v[76:79], a[172:175], a[84:87], v[76:79]
    s_waitcnt vmcnt(6)
    v_mfma_f32_16x16x32_bf16 v[48:51], a[176:179], a[88:91], v[48:51]
    s_waitcnt vmcnt(4)
    v_mfma_f32_16x16x32_bf16 v[48:51], a[192:195], a[96:99], v[48:51]
    s_waitcnt vmcnt(2)
    v_mfma_f32_16x16x32_bf16 v[48:51], a[208:211], a[104:107], v[48:51]
    v_mfma_f32_16x16x32_bf16 v[52:55], a[176:179], a[92:95], v[52:55]
    v_mfma_f32_16x16x32_bf16 v[52:55], a[192:195], a[100:103], v[52:55]
    s_waitcnt vmcnt(1)
    v_mfma_f32_16x16x32_bf16 v[52:55], a[208:211], a[108:111], v[52:55]
    v_mfma_f32_16x16x32_bf16 v[56:59], a[180:183], a[88:91], v[56:59]
    s_nop 1
    v_mfma_f32_16x16x32_bf16 v[56:59], a[196:199], a[96:99], v[56:59]
    s_nop 1
    v_mfma_f32_16x16x32_bf16 v[56:59], a[212:215], a[104:107], v[56:59]
    ds_write_b128 v13, v[48:51] offset:38912
    s_nop 0
    v_mfma_f32_16x16x32_bf16 v[60:63], a[180:183], a[92:95], v[60:63]
    ds_write_b128 v13, v[52:55] offset:39936
    v_mfma_f32_16x16x32_bf16 v[60:63], a[196:199], a[100:103], v[60:63]
    v_mfma_f32_16x16x32_bf16 v[60:63], a[212:215], a[108:111], v[60:63]
    v_mfma_f32_16x16x32_bf16 v[64:67], a[184:187], a[88:91], v[64:67]
    s_nop 1
    v_mfma_f32_16x16x32_bf16 v[64:67], a[200:203], a[96:99], v[64:67]
    s_nop 1
    v_mfma_f32_16x16x32_bf16 v[64:67], a[216:219], a[104:107], v[64:67]
    ds_write_b128 v9, v[56:59] offset:34816
    s_nop 0
    v_mfma_f32_16x16x32_bf16 v[68:71], a[184:187], a[92:95], v[68:71]
    ds_write_b128 v9, v[60:63] offset:35840
    v_mfma_f32_16x16x32_bf16 v[68:71], a[200:203], a[100:103], v[68:71]
    v_mfma_f32_16x16x32_bf16 v[68:71], a[216:219], a[108:111], v[68:71]
    v_mfma_f32_16x16x32_bf16 v[72:75], a[188:191], a[88:91], v[72:75]
    s_nop 1
    v_mfma_f32_16x16x32_bf16 v[72:75], a[204:207], a[96:99], v[72:75]
    s_nop 1
    v_mfma_f32_16x16x32_bf16 v[72:75], a[220:223], a[104:107], v[72:75]
    ds_write_b128 v11, v[64:67] offset:36864
    s_nop 0
    v_mfma_f32_16x16x32_bf16 v[76:79], a[188:191], a[92:95], v[76:79]
    ds_write_b128 v11, v[68:71] offset:37888
    v_mfma_f32_16x16x32_bf16 v[76:79], a[204:207], a[100:103], v[76:79]
    v_mfma_f32_16x16x32_bf16 v[76:79], a[220:223], a[108:111], v[76:79]
    s_branch M_TAIL
SLOWN1:
    s_mov_b32 s55, 0
REDO1:
    s_nop 15
    s_add_u32 s3, s53, s24
    buffer_load_dwordx4 a[0:3], v2, s[8:11], s3 offen sc1
    buffer_load_dwordx4 a[4:7], v2, s[8:11], s3 offen offset:1024 sc1
    s_add_u32 s3, s53, s25
    buffer_load_dwordx4 a[8:11], v2, s[8:11], s3 offen sc1
    buffer_load_dwordx4 a[12:15], v2, s[8:11], s3 offen offset:1024 sc1
    s_add_u32 s3, s53, s26
    buffer_load_dwordx4 a[16:19], v2, s[8:11], s3 offen sc1
    buffer_load_dwordx4 a[20:23], v2, s[8:11], s3 offen offset:1024 sc1
    s_add_u32 s3, s53, s27
    buffer_load_dwordx4 a[24:27], v2, s[8:11], s3 offen sc1
    buffer_load_dwordx4 a[28:31], v2, s[8:11], s3 offen offset:1024 sc1
    s_add_u32 s3, s53, s33
    buffer_load_dwordx4 a[32:35], v2, s[8:11], s3 offen sc1
    buffer_load_dwordx4 a[36:39], v2, s[8:11], s3 offen offset:1024 sc1
    s_add_u32 s3, s53, s38
    buffer_load_dwordx4 a[40:43], v2, s[8:11], s3 offen sc1
    buffer_load_dwordx4 a[44:47], v2, s[8:11], s3 offen offset:1024 sc1
    s_add_u32 s3, s53, s32
    buffer_load_dwordx4 a[48:51], v2, s[8:11], s3 offen sc1
    buffer_load_dwordx4 a[52:55], v2, s[8:11], s3 offen offset:1024 sc1
    s_add_u32 s3, s35, s24
    buffer_load_dwordx4 a[56:59], v2, s[8:11], s3 offen sc1
    buffer_load_dwordx4 a[60:63], v2, s[8:11], s3 offen offset:1024 sc1
    s_add_u32 s3, s35, s25
    buffer_load_dwordx4 a[64:67], v2, s[8:11], s3 offen sc1
    buffer_load_dwordx4 a[68:71], v2, s[8:11], s3 offen offset:1024 sc1
    s_add_u32 s3, s35, s26
    buffer_load_dwordx4 a[72:75], v2, s[8:11], s3 offen sc1
    buffer_load_dwordx4 a[76:79], v2, s[8:11], s3 offen offset:1024 sc1
    s_add_u32 s3, s35, s27
    buffer_load_dwordx4 a[80:83], v2, s[8:11], s3 offen sc1
    buffer_load_dwordx4 a[84:87], v2, s[8:11], s3 offen offset:1024 sc1
    s_add_u32 s3, s35, s33
    buffer_load_dwordx4 a[88:91], v2, s[8:11], s3 offen sc1
    buffer_load_dwordx4 a[92:95], v2, s[8:11], s3 offen offset:1024 sc1
    s_add_u32 s3, s35, s38
    buffer_load_dwordx4 a[96:99], v2, s[8:11], s3 offen sc1
    buffer_load_dwordx4 a[100:103], v2, s[8:11], s3 offen offset:1024 sc1
    s_add_u32 s3, s35, s32
    buffer_load_dwordx4 a[104:107], v2, s[8:11], s3 offen sc1
    buffer_load_dwordx4 a[108:111], v2, s[8:11], s3 offen offset:1024 sc1
    s_waitcnt vmcnt(0) lgkmcnt(0)
    v_mfma_f32_16x16x32_bf16 v[48:51], a[224:227], a[0:3], 0
    v_mfma_f32_16x16x32_bf16 v[48:51], a[240:243], a[8:11], v[48:51]
    v_mfma_f32_16x16x32_bf16 v[52:55], a[224:227], a[4:7], 0
    v_mfma_f32_16x16x32_bf16 v[52:55], a[240:243], a[12:15], v[52:55]
    v_mfma_f32_16x16x32_bf16 v[56:59], a[228:231], a[0:3], 0
    v_mfma_f32_16x16x32_bf16 v[56:59], a[244:247], a[8:11], v[56:59]
    v_mfma_f32_16x16x32_bf16 v[60:63], a[228:231], a[4:7], 0
    v_mfma_f32_16x16x32_bf16 v[60:63], a[244:247], a[12:15], v[60:63]
    v_mfma_f32_16x16x32_bf16 v[64:67], a[232:235], a[0:3], 0
    v_mfma_f32_16x16x32_bf16 v[64:67], a[248:251], a[8:11], v[64:67]
    v_mfma_f32_16x16x32_bf16 v[68:71], a[232:235], a[4:7], 0
    v_mfma_f32_16x16x32_bf16 v[68:71], a[248:251], a[12:15], v[68:71]
    v_mfma_f32_16x16x32_bf16 v[72:75], a[236:239], a[0:3], 0
    v_mfma_f32_16x16x32_bf16 v[72:75], a[252:255], a[8:11], v[72:75]
    v_mfma_f32_16x16x32_bf16 v[76:79], a[236:239], a[4:7], 0
    v_mfma_f32_16x16x32_bf16 v[76:79], a[252:255], a[12:15], v[76:79]
    v_mfma_f32_16x16x32_bf16 v[48:51], v[208:211], a[16:19], v[48:51]
    v_mfma_f32_16x16x32_bf16 v[48:51], v[224:227], a[24:27], v[48:51]
    v_mfma_f32_16x16x32_bf16 v[52:55], v[208:211], a[20:23], v[52:55]
    v_mfma_f32_16x16x32_bf16 v[52:55], v[224:227], a[28:31], v[52:55]
    v_mfma_f32_16x16x32_bf16 v[56:59], v[212:215], a[16:19], v[56:59]
    v_mfma_f32_16x16x32_bf16 v[56:59], v[228:231], a[24:27], v[56:59]
    v_mfma_f32_16x16x32_bf16 v[60:63], v[212:215], a[20:23], v[60:63]
    v_mfma_f32_16x16x32_bf16 v[60:63], v[228:231], a[28:31], v[60:63]
    v_mfma_f32_16x16x32_bf16 v[64:67], v[216:219], a[16:19], v[64:67]
    v_mfma_f32_16x16x32_bf16 v[64:67], v[232:235], a[24:27], v[64:67]
    v_mfma_f32_16x16x32_bf16 v[68:71], v[216:219], a[20:23], v[68:71]
    v_mfma_f32_16x16x32_bf16 v[68:71], v[232:235], a[28:31], v[68:71]
    v_mfma_f32_16x16x32_bf16 v[72:75], v[220:223], a[16:19], v[72:75]
    v_mfma_f32_16x16x32_bf16 v[72:75], v[236:239], a[24:27], v[72:75]
    v_mfma_f32_16x16x32_bf16 v[76:79], v[220:223], a[20:23], v[76:79]
    v_mfma_f32_16x16x32_bf16 v[76:79], v[236:239], a[28:31], v[76:79]
    v_mfma_f32_16x16x32_bf16 v[48:51], v[240:243], a[32:35], v[48:51]
    v_mfma_f32_16x16x32_bf16 v[48:51], v[176:179], a[40:43], v[48:51]
    v_mfma_f32_16x16x32_bf16 v[48:51], v[112:115], a[48:51], v[48:51]
    v_mfma_f32_16x16x32_bf16 v[52:55], v[240:243], a[36:39], v[52:55]
    v_mfma_f32_16x16x32_bf16 v[52:55], v[176:179], a[44:47], v[52:55]
    v_mfma_f32_16x16x32_bf16 v[52:55], v[112:115], a[52:55], v[52:55]
    v_mfma_f32_16x16x32_bf16 v[56:59], v[244:247], a[32:35], v[56:59]
    v_mfma_f32_16x16x32_bf16 v[56:59], v[180:183], a[40:43], v[56:59]
    v_mfma_f32_16x16x32_bf16 v[56:59], v[116:119], a[48:51], v[56:59]
    v_mfma_f32_16x16x32_bf16 v[60:63], v[244:247], a[36:39], v[60:63]
    v_mfma_f32_16x16x32_bf16 v[60:63], v[180:183], a[44:47], v[60:63]
    v_mfma_f32_16x16x32_bf16 v[60:63], v[116:119], a[52:55], v[60:63]
    v_mfma_f32_16x16x32_bf16 v[64:67], v[248:251], a[32:35], v[64:67]
    v_mfma_f32_16x16x32_bf16 v[64:67], v[128:131], a[40:43], v[64:67]
    v_mfma_f32_16x16x32_bf16 v[64:67], v[120:123], a[48:51], v[64:67]
    v_mfma_f32_16x16x32_bf16 v[68:71], v[248:251], a[36:39], v[68:71]
    v_mfma_f32_16x16x32_bf16 v[68:71], v[128:131], a[44:47], v[68:71]
    v_mfma_f32_16x16x32_bf16 v[68:71], v[120:123], a[52:55], v[68:71]
    v_mfma_f32_16x16x32_bf16 v[72:75], v[252:255], a[32:35], v[72:75]
    v_mfma_f32_16x16x32_bf16 v[72:75], v[132:135], a[40:43], v[72:75]
    v_mfma_f32_16x16x32_bf16 v[72:75], v[124:127], a[48:51], v[72:75]
    v_mfma_f32_16x16x32_bf16 v[76:79], v[252:255], a[36:39], v[76:79]
    v_mfma_f32_16x16x32_bf16 v[76:79], v[132:135], a[44:47], v[76:79]
    v_mfma_f32_16x16x32_bf16 v[76:79], v[124:127], a[52:55], v[76:79]
    v_mfma_f32_16x16x32_bf16 v[48:51], a[112:115], a[56:59], v[48:51]
    v_mfma_f32_16x16x32_bf16 v[48:51], a[128:131], a[64:67], v[48:51]
    v_mfma_f32_16x16x32_bf16 v[52:55], a[112:115], a[60:63], v[52:55]
    v_mfma_f32_16x16x32_bf16 v[52:55], a[128:131], a[68:71], v[52:55]
    v_mfma_f32_16x16x32_bf16 v[56:59], a[116:119], a[56:59], v[56:59]
    v_mfma_f32_16x16x32_bf16 v[56:59], a[132:135], a[64:67], v[56:59]
    v_mfma_f32_16x16x32_bf16 v[60:63], a[116:119], a[60:63], v[60:63]
    v_mfma_f32_16x16x32_bf16 v[60:63], a[132:135], a[68:71], v[60:63]
    v_mfma_f32_16x16x32_bf16 v[64:67], a[120:123], a[56:59], v[64:67]
    v_mfma_f32_16x16x32_bf16 v[64:67], a[136:139], a[64:67], v[64:67]
    v_mfma_f32_16x16x32_bf16 v[68:71], a[120:123], a[60:63], v[68:71]
    v_mfma_f32_16x16x32_bf16 v[68:71], a[136:139], a[68:71], v[68:71]
    v_mfma_f32_16x16x32_bf16 v[72:75], a[124:127], a[56:59], v[72:75]
    v_mfma_f32_16x16x32_bf16 v[72:75], a[140:143], a[64:67], v[72:75]
    v_mfma_f32_16x16x32_bf16 v[76:79], a[124:127], a[60:63], v[76:79]
    v_mfma_f32_16x16x32_bf16 v[76:79], a[140:143], a[68:71], v[76:79]
    v_mfma_f32_16x16x32_bf16 v[48:51], a[144:147], a[72:75], v[48:51]
    v_mfma_f32_16x16x32_bf16 v[48:51], a[160:163], a[80:83], v[48:51]
    v_mfma_f32_16x16x32_bf16 v[52:55], a[144:147], a[76:79], v[52:55]
    v_mfma_f32_16x16x32_bf16 v[52:55], a[160:163], a[84:87], v[52:55]
    v_mfma_f32_16x16x32_bf16 v[56:59], a[148:151], a[72:75], v[56:59]
    v_mfma_f32_16x16x32_bf16 v[56:59], a[164:167], a[80:83], v[56:59]
    v_mfma_f32_16x16x32_bf16 v[60:63], a[148:151], a[76:79], v[60:63]
    v_mfma_f32_16x16x32_bf16 v[60:63], a[164:167], a[84:87], v[60:63]
    v_mfma_f32_16x16x32_bf16 v[64:67], a[152:155], a[72:75], v[64:67]
    v_mfma_f32_16x16x32_bf16 v[64:67], a[168:171], a[80:83], v[64:67]
    v_mfma_f32_16x16x32_bf16 v[68:71], a[152:155], a[76:79], v[68:71]
    v_mfma_f32_16x16x32_bf16 v[68:71], a[168:171], a[84:87], v[68:71]
    v_mfma_f32_16x16x32_bf16 v[72:75], a[156:159], a[72:75], v[72:75]
    v_mfma_f32_16x16x32_bf16 v[72:75], a[172:175], a[80:83], v[72:75]
    v_mfma_f32_16x16x32_bf16 v[76:79], a[156:159], a[76:79], v[76:79]
    v_mfma_f32_16x16x32_bf16 v[76:79], a[172:175], a[84:87], v[76:79]
    v_mfma_f32_16x16x32_bf16 v[48:51], a[176:179], a[88:91], v[48:51]
    v_mfma_f32_16x16x32_bf16 v[48:51], a[192:195], a[96:99], v[48:51]
    v_mfma_f32_16x16x32_bf16 v[48:51], a[208:211], a[104:107], v[48:51]
    v_mfma_f32_16x16x32_bf16 v[52:55], a[176:179], a[92:95], v[52:55]
    v_mfma_f32_16x16x32_bf16 v[52:55], a[192:195], a[100:103], v[52:55]
    v_mfma_f32_16x16x32_bf16 v[52:55], a[208:211], a[108:111], v[52:55]
    v_mfma_f32_16x16x32_bf16 v[56:59], a[180:183], a[88:91], v[56:59]
    v_mfma_f32_16x16x32_bf16 v[56:59], a[196:199], a[96:99], v[56:59]
    v_mfma_f32_16x16x32_bf16 v[56:59], a[212:215], a[104:107], v[56:59]
    v_mfma_f32_16x16x32_bf16 v[60:63], a[180:183], a[92:95], v[60:63]
    v_mfma_f32_16x16x32_bf16 v[60:63], a[196:199], a[100:103], v[60:63]
    v_mfma_f32_16x16x32_bf16 v[60:63], a[212:215], a[108:111], v[60:63]
    v_mfma_f32_16x16x32_bf16 v[64:67], a[184:187], a[88:91], v[64:67]
    v_mfma_f32_16x16x32_bf16 v[64:67], a[200:203], a[96:99], v[64:67]
    v_mfma_f32_16x16x32_bf16 v[64:67], a[216:219], a[104:107], v[64:67]
    v_mfma_f32_16x16x32_bf16 v[68:71], a[184:187], a[92:95], v[68:71]
    v_mfma_f32_16x16x32_bf16 v[68:71], a[200:203], a[100:103], v[68:71]
    v_mfma_f32_16x16x32_bf16 v[68:71], a[216:219], a[108:111], v[68:71]
    v_mfma_f32_16x16x32_bf16 v[72:75], a[188:191], a[88:91], v[72:75]
    v_mfma_f32_16x16x32_bf16 v[72:75], a[204:207], a[96:99], v[72:75]
    v_mfma_f32_16x16x32_bf16 v[72:75], a[220:223], a[104:107], v[72:75]
    v_mfma_f32_16x16x32_bf16 v[76:79], a[188:191], a[92:95], v[76:79]
    v_mfma_f32_16x16x32_bf16 v[76:79], a[204:207], a[100:103], v[76:79]
    v_mfma_f32_16x16x32_bf16 v[76:79], a[220:223], a[108:111], v[76:79]
    s_nop 15
    ds_write_b128 v13, v[48:51] offset:38912
    ds_write_b128 v13, v[52:55] offset:39936
    ds_write_b128 v9, v[56:59] offset:34816
    ds_write_b128 v9, v[60:63] offset:35840
    ds_write_b128 v11, v[64:67] offset:36864
    ds_write_b128 v11, v[68:71] offset:37888
    v_cmp_u_f32 vcc, v48, v52
    s_add_u32 s55, s55, 1
    s_cbranch_vccz REDOD1
    s_cmp_lt_u32 s55, 64
    s_cbranch_scc1 REDO1
REDOD1:
    s_branch BACKN1
.section .rodata,"a"
.p2align 6
.amdhsa_kernel adaLN_cond__spectral_fnet__glu_gated_glu__prompt_kernel
  .amdhsa_next_free_vgpr 512
  .amdhsa_next_free_sgpr 60
  .amdhsa_accum_offset 256
  .amdhsa_group_segment_fixed_size 0
  .amdhsa_kernarg_size 112
  .amdhsa_user_sgpr_count 2
  .amdhsa_user_sgpr_kernarg_segment_ptr 1
  .amdhsa_system_sgpr_workgroup_id_x 1
  .amdhsa_float_denorm_mode_32 3
.end_amdhsa_kernel
```
